```python
import torch

def _softmax(x, axis=-1):
    return torch.softmax(x, dim=axis)

def _gelu(x):
    return torch.nn.functional.gelu(x, approximate='tanh')

def _silu(x):
    return torch.nn.functional.silu(x)

def _sigmoid(x):
    return torch.sigmoid(x)

def _layernorm(x, axis=-1, eps=1e-05):
    m = x.mean(dim=axis, keepdim=True)
    v = x.var(dim=axis, keepdim=True, unbiased=False)
    return (x - m) / torch.sqrt(v + eps)

def _scatter_add(tgt, idx, src, axis=0):
    return tgt.clone().index_add_(axis, idx, src)

def _segment_sum(src, seg, n):
    out = torch.zeros((n,) + src.shape[1:], dtype=src.dtype)
    return out.index_add_(0, seg, src)

def _pad(x, pw):
    flat = tuple((v for pair in reversed(pw) for v in pair))
    return torch.nn.functional.pad(x, flat)
kernel_name = 'adaLN_cond__sliding_block_cached__dense_activation_relu__decode'

def setup_inputs():

    _w = lambda a: (lambda t: t.to(torch.bfloat16) if t.is_floating_point() else t)(torch.as_tensor(a))

    def _A_setup():
        B, Sq, D = (1, 1, 640)
        Hq, Hkv, Sk, Dh = (32, 32, 16384, 128)
        assert Hq % Hkv == 0, (Hq, Hkv)
        return {'x': _w((lambda *s: torch.randn(*s, dtype=torch.bfloat16) * 0.05)(B, Sq, D)), 'k_cache': _w((lambda *s: torch.randn(*s, dtype=torch.bfloat16) * 3.2)(B, Hkv, Sk, Dh)), 'v_cache': _w((lambda *s: torch.randn(*s, dtype=torch.bfloat16) * 0.4)(B, Hkv, Sk, Dh)), 'wq': _w((lambda *s: torch.randn(*s, dtype=torch.bfloat16) * 3.2)(D, Hq * Dh) * D ** (-0.5)), 'wo': _w((lambda *s: torch.randn(*s, dtype=torch.bfloat16) * 0.4)(Hq * Dh, D) * (Hq * Dh) ** (-0.5))}
    _A_in = _A_setup()

    def _B_setup():
        B, S, D, Dff = (1, 1, 640, 1728)
        return {'x': _w((lambda *s: torch.randn(*s, dtype=torch.bfloat16) * 0.05)(B, S, D)), 'w1': _w((lambda *s: torch.randn(*s, dtype=torch.bfloat16) * 0.05)(D, Dff)), 'w2': _w((lambda *s: torch.randn(*s, dtype=torch.bfloat16) * 0.05)(Dff, D))}
    _B_in = _B_setup()
    return {'A_x': _A_in['x'], 'A_k_cache': _A_in['k_cache'], 'A_v_cache': _A_in['v_cache'], 'A_wq': _A_in['wq'], 'A_wo': _A_in['wo'], 'B_x': _B_in['x'], 'B_w1': _B_in['w1'], 'B_w2': _B_in['w2'], 'c': _w((lambda *s: torch.randn(*s, dtype=torch.bfloat16) * 0.1)(1, 640) * 8.0), 'w_mod': _w((lambda *s: torch.randn(*s, dtype=torch.bfloat16) * 0.1)(640, 6 * 640) * 640 ** (-0.5) * 8.0)}

def reference(A_x, A_k_cache, A_v_cache, A_wq, A_wo, B_x, B_w1, B_w2, c, w_mod):

    def _A_ref(x, k_cache, v_cache, wq, wo):
        B, Sq, D = x.shape
        Hq, Dh = (32, 128)
        Hkv, Sk = (k_cache.shape[1], k_cache.shape[2])
        W = min(4096, max(256, Sk // 4))
        rep = Hq // Hkv
        q = (lambda x, *d: x.permute(*d))((x @ wq).reshape(B, Sq, Hq, Dh), 0, 2, 1, 3)
        k = (lambda x, n, axis: torch.repeat_interleave(x, n, dim=axis))(k_cache[:, :, Sk - W:, :], rep, axis=1)
        v = (lambda x, n, axis: torch.repeat_interleave(x, n, dim=axis))(v_cache[:, :, Sk - W:, :], rep, axis=1)
        scores = torch.einsum('bhqd,bhkd->bhqk', q, k) * Dh ** (-0.5)
        p = _softmax(scores, axis=-1)
        o = torch.einsum('bhqk,bhkd->bhqd', p, v)
        return (lambda x, *d: x.permute(*d))(o, 0, 2, 1, 3).reshape(B, Sq, Hq * Dh) @ wo

    def _B_ref(x, w1, w2):
        h = torch.einsum('bsd,df->bsf', x, w1)
        zero = torch.zeros_like(h)
        h = torch.maximum(h, zero)
        return torch.einsum('bsf,fd->bsd', h, w2)
    x = A_x
    mod = (_silu(c) @ w_mod).reshape(c.shape[0], 6, 1, -1)
    sa, ca, ga, sb, cb, gb = (mod[:, 0].clone(), mod[:, 1].clone(), mod[:, 2].clone(), mod[:, 3].clone(), mod[:, 4].clone(), mod[:, 5].clone())
    h = _layernorm(x, axis=-1) * (1 + ca) + sa
    x = x + ga * _A_ref(h, A_k_cache, A_v_cache, A_wq, A_wo)
    h = _layernorm(x, axis=-1) * (1 + cb) + sb
    x = x + gb * _B_ref(h, B_w1, B_w2)
    return x
```

```asm
; @launch grid=(256,1,1) block=(768,1,1) lds=110592
.amdgcn_target "amdgcn-amd-amdhsa--gfx950"
.text
.globl adaLN_cond__sliding_block_cached__dense_activation_relu__decode_kernel
.p2align 8
.type adaLN_cond__sliding_block_cached__dense_activation_relu__decode_kernel,@function
adaLN_cond__sliding_block_cached__dense_activation_relu__decode_kernel:
    s_cmp_ge_u32 s2, 256
    s_cbranch_scc1 L_end

    s_load_dwordx16 s[36:51], s[0:1], 0
    s_load_dwordx8 s[52:59], s[0:1], 64
    s_load_dwordx2 s[60:61], s[0:1], 96
    v_lshrrev_b32 v1, 6, v0
    v_and_b32 v0, 63, v0
    s_nop 0
    v_readfirstlane_b32 s3, v1
    s_and_b32 s4, s2, 7
    s_lshr_b32 s101, s2, 3
    s_and_b32 s5, s101, 0x18
    s_add_u32 s33, s4, s5
    s_and_b32 s34, s101, 7
    s_sub_u32 s35, s2, 160
    s_cmp_lt_u32 s101, 20
    s_cselect_b32 s35, 1000, s35
    s_lshr_b32 s5, s35, 4
    s_lshl_b32 s5, s5, 4
    s_lshl_b32 s6, s4, 1
    s_add_u32 s5, s5, s6
    s_bfe_u32 s6, s35, 0x10003
    s_add_u32 s5, s5, s6
    s_cmp_lt_u32 s35, 48
    s_cselect_b32 s35, s5, s35
    s_mov_b32 s62, 84148480
    s_mov_b32 s63, 117834498
    v_lshlrev_b32 v1, 4, v0
    v_mov_b32 v2, 0
    s_waitcnt lgkmcnt(0)
    s_load_dword s32, s[60:61], 0

    s_mov_b32 s16, s60
    s_mov_b32 s17, s61
    s_mov_b32 s18, 536870912
    s_mov_b32 s19, 0x00020000

    s_cmp_ge_u32 s3, 8
    s_cbranch_scc1 L_comm

    s_mov_b32 s8, s38
    s_mov_b32 s9, s39
    s_mov_b32 s10, 134217728
    s_mov_b32 s11, 0x00020000

    s_mov_b32 s12, s40
    s_mov_b32 s13, s41
    s_mov_b32 s14, 134217728
    s_mov_b32 s15, 0x00020000

    s_mov_b32 s20, s44
    s_mov_b32 s21, s45
    s_mov_b32 s22, 5242880
    s_mov_b32 s23, 0x00020000

    s_lshl_b32 s28, s33, 22
    s_lshl_b32 s29, s34, 17
    s_add_u32 s28, s28, s29
    s_add_u32 s28, s28, 3145728
    s_lshl_b32 s29, s3, 14
    s_add_u32 s28, s28, s29
    s_add_u32 s29, s2, s3
    s_add_u32 s29, s29, s101

    s_add_u32 s4, s29, 0
    s_and_b32 s4, s4, 3
    s_lshl_b32 s4, s4, 12
    s_add_u32 s24, s28, s4
    s_add_u32 s4, s29, 1
    s_and_b32 s4, s4, 3
    s_lshl_b32 s4, s4, 12
    s_add_u32 s25, s28, s4
    s_add_u32 s4, s29, 2
    s_and_b32 s4, s4, 3
    s_lshl_b32 s4, s4, 12
    s_add_u32 s26, s28, s4
    s_add_u32 s4, s29, 3
    s_and_b32 s4, s4, 3
    s_lshl_b32 s4, s4, 12
    s_add_u32 s27, s28, s4
    s_mov_b32 s100, 0
    buffer_load_dwordx4 v[8:11], v1, s[8:11], s24 offen offset:0 nt
    buffer_load_dwordx4 v[12:15], v1, s[8:11], s24 offen offset:1024 nt
    buffer_load_dwordx4 v[16:19], v1, s[8:11], s24 offen offset:2048 nt
    s_barrier
    v_and_b32 v164, 15, v0
    v_lshlrev_b32 v164, 3, v164
    v_lshrrev_b32 v4, 5, v0
    v_lshl_add_u32 v164, v4, 2, v164
    v_bfe_u32 v4, v0, 4, 1
    v_lshl_add_u32 v164, v4, 1, v164

    s_lshl_b32 s4, s3, 9
    v_lshl_add_u32 v165, v164, 2, s4
    v_and_b32 v3, 15, v0
    v_lshrrev_b32 v4, 4, v0
    v_lshlrev_b32 v5, 10, v4
    v_lshl_add_u32 v166, v3, 4, v5
    v_and_b32 v3, 7, v0
    v_lshrrev_b32 v4, 3, v0
    v_mul_u32_u24 v4, 2560, v4
    v_lshl_add_u32 v167, v3, 4, v4
    s_cmp_ge_u32 s101, 10
    s_cselect_b32 s6, 1, 0
    s_mul_i32 s7, s6, 10
    s_sub_u32 s7, s101, s7
    s_lshl_b32 s6, s6, 1
    s_lshr_b32 s5, s3, 2
    s_add_u32 s6, s6, s5
    s_lshl_b32 s6, s6, 3
    s_and_b32 s4, s2, 7
    s_add_u32 s4, s4, s6
    s_and_b32 s5, s3, 3
    s_lshl_b32 s6, s4, 2
    s_add_u32 s6, s6, s5
    s_mul_i32 s28, s6, 40960
    s_lshl_b32 s7, s7, 7
    s_add_u32 s28, s28, s7
    s_cmp_lt_u32 s101, 20
    s_cselect_b32 s28, s28, 0x7f000000
    s_lshl_b32 s4, s4, 13
    s_lshl_b32 s5, s5, 8
    s_add_u32 s4, s4, s5
    s_add_u32 s29, s4, 393216

    s_cmp_lt_u32 s35, 54
    s_cbranch_scc1 Lt_1
    s_waitcnt vmcnt(2)
    s_branch Lt_2
Lt_1:
    s_waitcnt vmcnt(3)
Lt_2:
    buffer_load_dwordx4 v[20:23], v1, s[8:11], s24 offen offset:3072 nt
    s_cmp_lt_u32 s35, 54
    s_cbranch_scc1 Lt_3
    s_waitcnt vmcnt(2)
    s_branch Lt_4
Lt_3:
    s_waitcnt vmcnt(3)
Lt_4:
    buffer_load_dwordx4 v[24:27], v1, s[8:11], s25 offen offset:0 nt
    s_cmp_lt_u32 s35, 54
    s_cbranch_scc1 Lt_5
    s_waitcnt vmcnt(2)
    s_branch Lt_6
Lt_5:
    s_waitcnt vmcnt(3)
Lt_6:
    buffer_load_dwordx4 v[28:31], v1, s[8:11], s25 offen offset:1024 nt
    s_cmp_lt_u32 s35, 54
    s_cbranch_scc1 Lt_7
    s_waitcnt vmcnt(2)
    s_branch Lt_8
Lt_7:
    s_waitcnt vmcnt(3)
Lt_8:
    buffer_load_dwordx4 v[32:35], v1, s[8:11], s25 offen offset:2048 nt
    s_cmp_lt_u32 s35, 54
    s_cbranch_scc1 Lt_9
    s_waitcnt vmcnt(2)
    s_branch Lt_10
Lt_9:
    s_waitcnt vmcnt(3)
Lt_10:
    buffer_load_dwordx4 v[36:39], v1, s[8:11], s25 offen offset:3072 nt
    s_cmp_lt_u32 s35, 54
    s_cbranch_scc1 Lt_11
    s_waitcnt vmcnt(2)
    s_branch Lt_12
Lt_11:
    s_waitcnt vmcnt(3)
Lt_12:
    buffer_load_dwordx4 v[40:43], v1, s[8:11], s26 offen offset:0 nt
    s_cmp_lt_u32 s35, 54
    s_cbranch_scc1 Lt_13
    s_waitcnt vmcnt(2)
    s_branch Lt_14
Lt_13:
    s_waitcnt vmcnt(3)
Lt_14:
    buffer_load_dwordx4 v[44:47], v1, s[8:11], s26 offen offset:1024 nt
    s_cmp_lt_u32 s35, 54
    s_cbranch_scc1 Lt_15
    s_waitcnt vmcnt(2)
    s_branch Lt_16
Lt_15:
    s_waitcnt vmcnt(3)
Lt_16:
    buffer_load_dwordx4 v[48:51], v1, s[8:11], s26 offen offset:2048 nt
    s_cmp_lt_u32 s35, 54
    s_cbranch_scc1 Lt_17
    s_waitcnt vmcnt(2)
    s_branch Lt_18
Lt_17:
    s_waitcnt vmcnt(3)
Lt_18:
    buffer_load_dwordx4 v[52:55], v1, s[8:11], s26 offen offset:3072 nt
    s_cmp_lt_u32 s35, 54
    s_cbranch_scc1 Lt_19
    s_waitcnt vmcnt(2)
    s_branch Lt_20
Lt_19:
    s_waitcnt vmcnt(3)
Lt_20:
    buffer_load_dwordx4 v[56:59], v1, s[8:11], s27 offen offset:0 nt
    s_cmp_lt_u32 s35, 54
    s_cbranch_scc1 Lt_21
    s_waitcnt vmcnt(2)
    s_branch Lt_22
Lt_21:
    s_waitcnt vmcnt(3)
Lt_22:
    buffer_load_dwordx4 v[60:63], v1, s[8:11], s27 offen offset:1024 nt
    s_cmp_lt_u32 s35, 54
    s_cbranch_scc1 Lt_23
    s_waitcnt vmcnt(2)
    s_branch Lt_24
Lt_23:
    s_waitcnt vmcnt(3)
Lt_24:
    buffer_load_dwordx4 v[64:67], v1, s[8:11], s27 offen offset:2048 nt
    s_cmp_lt_u32 s35, 54
    s_cbranch_scc1 Lt_25
    s_waitcnt vmcnt(2)
    s_branch Lt_26
Lt_25:
    s_waitcnt vmcnt(3)
Lt_26:
    buffer_load_dwordx4 v[68:71], v1, s[8:11], s27 offen offset:3072 nt
    s_cmp_lt_u32 s35, 54
    s_cbranch_scc1 Lt_27
    s_waitcnt vmcnt(2)
    s_branch Lt_28
Lt_27:
    s_waitcnt vmcnt(3)
Lt_28:
    buffer_load_dwordx4 v[72:75], v1, s[12:15], s24 offen offset:0 nt
    s_cmp_lt_u32 s35, 54
    s_cbranch_scc1 Lt_29
    s_waitcnt vmcnt(2)
    s_branch Lt_30
Lt_29:
    s_waitcnt vmcnt(3)
Lt_30:
    buffer_load_dwordx4 v[76:79], v1, s[12:15], s24 offen offset:1024 nt
    s_cmp_lt_u32 s35, 54
    s_cbranch_scc1 Lt_31
    s_waitcnt vmcnt(2)
    s_branch Lt_32
Lt_31:
    s_waitcnt vmcnt(3)
Lt_32:
    buffer_load_dwordx4 v[80:83], v1, s[12:15], s24 offen offset:2048 nt
    s_cmp_lg_u32 s100, 0
    s_cbranch_scc1 Lup_34
    ds_read_b32 v6, v2 offset:0

    s_cmp_lt_u32 s35, 54
    s_cbranch_scc1 Lt_35
    s_waitcnt vmcnt(2) lgkmcnt(0)
    s_branch Lt_36
Lt_35:
    s_waitcnt vmcnt(3) lgkmcnt(0)
Lt_36:
    v_readfirstlane_b32 s100, v6
    s_branch Lnt_33

Lup_34:
    s_cmp_eq_u32 s100, 99
    s_cbranch_scc1 Lnt_33
    s_add_u32 s100, s100, 1
    s_cmp_le_u32 s100, 3
    s_cbranch_scc1 Lnt_33
    s_call_b64 s[98:99], L_qk

Lnt_33:
    buffer_load_dwordx4 v[84:87], v1, s[12:15], s24 offen offset:3072 nt
    s_cmp_lg_u32 s100, 0
    s_cbranch_scc1 Lup_38
    ds_read_b32 v6, v2 offset:0

    s_cmp_lt_u32 s35, 54
    s_cbranch_scc1 Lt_39
    s_waitcnt vmcnt(2) lgkmcnt(0)
    s_branch Lt_40
Lt_39:
    s_waitcnt vmcnt(3) lgkmcnt(0)
Lt_40:
    v_readfirstlane_b32 s100, v6
    s_branch Lnt_37

Lup_38:
    s_cmp_eq_u32 s100, 99
    s_cbranch_scc1 Lnt_37
    s_add_u32 s100, s100, 1
    s_cmp_le_u32 s100, 3
    s_cbranch_scc1 Lnt_37
    s_call_b64 s[98:99], L_qk

Lnt_37:
    buffer_load_dwordx4 v[88:91], v1, s[12:15], s25 offen offset:0 nt
    s_cmp_lg_u32 s100, 0
    s_cbranch_scc1 Lup_42
    ds_read_b32 v6, v2 offset:0

    s_cmp_lt_u32 s35, 54
    s_cbranch_scc1 Lt_43
    s_waitcnt vmcnt(2) lgkmcnt(0)
    s_branch Lt_44
Lt_43:
    s_waitcnt vmcnt(3) lgkmcnt(0)
Lt_44:
    v_readfirstlane_b32 s100, v6
    s_branch Lnt_41

Lup_42:
    s_cmp_eq_u32 s100, 99
    s_cbranch_scc1 Lnt_41
    s_add_u32 s100, s100, 1
    s_cmp_le_u32 s100, 3
    s_cbranch_scc1 Lnt_41
    s_call_b64 s[98:99], L_qk

Lnt_41:
    buffer_load_dwordx4 v[92:95], v1, s[12:15], s25 offen offset:1024 nt
    s_cmp_lg_u32 s100, 0
    s_cbranch_scc1 Lup_46
    ds_read_b32 v6, v2 offset:0

    s_cmp_lt_u32 s35, 54
    s_cbranch_scc1 Lt_47
    s_waitcnt vmcnt(2) lgkmcnt(0)
    s_branch Lt_48
Lt_47:
    s_waitcnt vmcnt(3) lgkmcnt(0)
Lt_48:
    v_readfirstlane_b32 s100, v6
    s_branch Lnt_45

Lup_46:
    s_cmp_eq_u32 s100, 99
    s_cbranch_scc1 Lnt_45
    s_add_u32 s100, s100, 1
    s_cmp_le_u32 s100, 3
    s_cbranch_scc1 Lnt_45
    s_call_b64 s[98:99], L_qk

Lnt_45:
    buffer_load_dwordx4 v[96:99], v1, s[12:15], s25 offen offset:2048 nt
    s_cmp_lg_u32 s100, 0
    s_cbranch_scc1 Lup_50
    ds_read_b32 v6, v2 offset:0

    s_cmp_lt_u32 s35, 54
    s_cbranch_scc1 Lt_51
    s_waitcnt vmcnt(2) lgkmcnt(0)
    s_branch Lt_52
Lt_51:
    s_waitcnt vmcnt(3) lgkmcnt(0)
Lt_52:
    v_readfirstlane_b32 s100, v6
    s_branch Lnt_49

Lup_50:
    s_cmp_eq_u32 s100, 99
    s_cbranch_scc1 Lnt_49
    s_add_u32 s100, s100, 1
    s_cmp_le_u32 s100, 3
    s_cbranch_scc1 Lnt_49
    s_call_b64 s[98:99], L_qk

Lnt_49:
    buffer_load_dwordx4 v[100:103], v1, s[12:15], s25 offen offset:3072 nt
    s_cmp_lg_u32 s100, 0
    s_cbranch_scc1 Lup_54
    ds_read_b32 v6, v2 offset:0

    s_cmp_lt_u32 s35, 54
    s_cbranch_scc1 Lt_55
    s_waitcnt vmcnt(2) lgkmcnt(0)
    s_branch Lt_56
Lt_55:
    s_waitcnt vmcnt(3) lgkmcnt(0)
Lt_56:
    v_readfirstlane_b32 s100, v6
    s_branch Lnt_53

Lup_54:
    s_cmp_eq_u32 s100, 99
    s_cbranch_scc1 Lnt_53
    s_add_u32 s100, s100, 1
    s_cmp_le_u32 s100, 3
    s_cbranch_scc1 Lnt_53
    s_call_b64 s[98:99], L_qk

Lnt_53:
    buffer_load_dwordx4 v[104:107], v1, s[12:15], s26 offen offset:0 nt
    s_cmp_lg_u32 s100, 0
    s_cbranch_scc1 Lup_58
    ds_read_b32 v6, v2 offset:0

    s_cmp_lt_u32 s35, 54
    s_cbranch_scc1 Lt_59
    s_waitcnt vmcnt(2) lgkmcnt(0)
    s_branch Lt_60
Lt_59:
    s_waitcnt vmcnt(3) lgkmcnt(0)
Lt_60:
    v_readfirstlane_b32 s100, v6
    s_branch Lnt_57

Lup_58:
    s_cmp_eq_u32 s100, 99
    s_cbranch_scc1 Lnt_57
    s_add_u32 s100, s100, 1
    s_cmp_le_u32 s100, 3
    s_cbranch_scc1 Lnt_57
    s_call_b64 s[98:99], L_qk

Lnt_57:
    buffer_load_dwordx4 v[108:111], v1, s[12:15], s26 offen offset:1024 nt
    s_cmp_lg_u32 s100, 0
    s_cbranch_scc1 Lup_62
    ds_read_b32 v6, v2 offset:0

    s_cmp_lt_u32 s35, 54
    s_cbranch_scc1 Lt_63
    s_waitcnt vmcnt(2) lgkmcnt(0)
    s_branch Lt_64
Lt_63:
    s_waitcnt vmcnt(3) lgkmcnt(0)
Lt_64:
    v_readfirstlane_b32 s100, v6
    s_branch Lnt_61

Lup_62:
    s_cmp_eq_u32 s100, 99
    s_cbranch_scc1 Lnt_61
    s_add_u32 s100, s100, 1
    s_cmp_le_u32 s100, 3
    s_cbranch_scc1 Lnt_61
    s_call_b64 s[98:99], L_qk

Lnt_61:
    buffer_load_dwordx4 v[112:115], v1, s[12:15], s26 offen offset:2048 nt
    s_cmp_lg_u32 s100, 0
    s_cbranch_scc1 Lup_66
    ds_read_b32 v6, v2 offset:0

    s_cmp_lt_u32 s35, 54
    s_cbranch_scc1 Lt_67
    s_waitcnt vmcnt(2) lgkmcnt(0)
    s_branch Lt_68
Lt_67:
    s_waitcnt vmcnt(3) lgkmcnt(0)
Lt_68:
    v_readfirstlane_b32 s100, v6
    s_branch Lnt_65

Lup_66:
    s_cmp_eq_u32 s100, 99
    s_cbranch_scc1 Lnt_65
    s_add_u32 s100, s100, 1
    s_cmp_le_u32 s100, 3
    s_cbranch_scc1 Lnt_65
    s_call_b64 s[98:99], L_qk

Lnt_65:
    buffer_load_dwordx4 v[116:119], v1, s[12:15], s26 offen offset:3072 nt
    s_cmp_lg_u32 s100, 0
    s_cbranch_scc1 Lup_70
    ds_read_b32 v6, v2 offset:0

    s_cmp_lt_u32 s35, 54
    s_cbranch_scc1 Lt_71
    s_waitcnt vmcnt(2) lgkmcnt(0)
    s_branch Lt_72
Lt_71:
    s_waitcnt vmcnt(3) lgkmcnt(0)
Lt_72:
    v_readfirstlane_b32 s100, v6
    s_branch Lnt_69

Lup_70:
    s_cmp_eq_u32 s100, 99
    s_cbranch_scc1 Lnt_69
    s_add_u32 s100, s100, 1
    s_cmp_le_u32 s100, 3
    s_cbranch_scc1 Lnt_69
    s_call_b64 s[98:99], L_qk

Lnt_69:
    buffer_load_dwordx4 v[120:123], v1, s[12:15], s27 offen offset:0 nt
    s_cmp_lg_u32 s100, 0
    s_cbranch_scc1 Lup_74
    ds_read_b32 v6, v2 offset:0

    s_cmp_lt_u32 s35, 54
    s_cbranch_scc1 Lt_75
    s_waitcnt vmcnt(2) lgkmcnt(0)
    s_branch Lt_76
Lt_75:
    s_waitcnt vmcnt(3) lgkmcnt(0)
Lt_76:
    v_readfirstlane_b32 s100, v6
    s_branch Lnt_73

Lup_74:
    s_cmp_eq_u32 s100, 99
    s_cbranch_scc1 Lnt_73
    s_add_u32 s100, s100, 1
    s_cmp_le_u32 s100, 3
    s_cbranch_scc1 Lnt_73
    s_call_b64 s[98:99], L_qk

Lnt_73:
    buffer_load_dwordx4 v[124:127], v1, s[12:15], s27 offen offset:1024 nt
    s_cmp_lg_u32 s100, 0
    s_cbranch_scc1 Lup_78
    ds_read_b32 v6, v2 offset:0

    s_cmp_lt_u32 s35, 54
    s_cbranch_scc1 Lt_79
    s_waitcnt vmcnt(2) lgkmcnt(0)
    s_branch Lt_80
Lt_79:
    s_waitcnt vmcnt(3) lgkmcnt(0)
Lt_80:
    v_readfirstlane_b32 s100, v6
    s_branch Lnt_77

Lup_78:
    s_cmp_eq_u32 s100, 99
    s_cbranch_scc1 Lnt_77
    s_add_u32 s100, s100, 1
    s_cmp_le_u32 s100, 3
    s_cbranch_scc1 Lnt_77
    s_call_b64 s[98:99], L_qk

Lnt_77:
    buffer_load_dwordx4 v[128:131], v1, s[12:15], s27 offen offset:2048 nt
    s_cmp_lg_u32 s100, 0
    s_cbranch_scc1 Lup_82
    ds_read_b32 v6, v2 offset:0

    s_cmp_lt_u32 s35, 54
    s_cbranch_scc1 Lt_83
    s_waitcnt vmcnt(2) lgkmcnt(0)
    s_branch Lt_84
Lt_83:
    s_waitcnt vmcnt(3) lgkmcnt(0)
Lt_84:
    v_readfirstlane_b32 s100, v6
    s_branch Lnt_81

Lup_82:
    s_cmp_eq_u32 s100, 99
    s_cbranch_scc1 Lnt_81
    s_add_u32 s100, s100, 1
    s_cmp_le_u32 s100, 3
    s_cbranch_scc1 Lnt_81
    s_call_b64 s[98:99], L_qk

Lnt_81:
    buffer_load_dwordx4 v[132:135], v1, s[12:15], s27 offen offset:3072 nt
    v_mov_b32 v3, 1
    s_mov_b64 exec, 1
    ds_add_u32 v2, v3 offset:40
    s_mov_b64 exec, -1
    s_cmp_eq_u32 s100, 99
    s_cbranch_scc1 Lsk_85
    s_mov_b32 s5, 0
Lspin_86:
    ds_read_b32 v3, v2 offset:0
    s_waitcnt lgkmcnt(0)
    v_readfirstlane_b32 s6, v3
    s_cmp_ge_u32 s6, 1
    s_cbranch_scc1 Lok_87
    s_sleep 1
    s_add_u32 s5, s5, 1
    s_cmp_lt_u32 s5, 1600000
    s_cbranch_scc1 Lspin_86
Lok_87:
    s_waitcnt vmcnt(16)
    s_call_b64 s[98:99], L_qk
Lsk_85:
    s_add_u32 s8, s60, 4194304
    s_addc_u32 s9, s61, 0
    s_mov_b32 s10, 532676608
    s_mov_b32 s11, 0x00020000

    s_lshl_b32 s24, s33, 3
    s_add_u32 s24, s24, s34
    s_lshl_b32 s24, s24, 10
    s_add_u32 s24, s24, 393216

    s_add_u32 s25, s24, 4194304
    s_sub_u32 s26, s29, 393216
    s_lshr_b32 s26, s26, 13
    s_lshl_b32 s26, s26, 7
    s_add_u32 s26, s26, 389120
    v_lshrrev_b32 v60, 4, v0
    v_lshlrev_b32 v60, 4, v60

    v_mov_b32 v41, s32
    v_mov_b32 v43, s32
    v_lshlrev_b32 v5, 3, v0
    v_mov_b32 v3, 1
    s_waitcnt vmcnt(14)
    v_perm_b32 v148, v76, v72, s62
    v_perm_b32 v150, v76, v72, s63
    v_dot2_f32_bf16 v140, v148, v156, 0
    v_dot2_f32_bf16 v141, v150, v156, 0
    v_perm_b32 v149, v77, v73, s62
    v_perm_b32 v151, v77, v73, s63
    v_dot2_f32_bf16 v142, v149, v156, 0
    v_dot2_f32_bf16 v143, v151, v156, 0
    v_perm_b32 v148, v78, v74, s62
    v_perm_b32 v150, v78, v74, s63
    v_dot2_f32_bf16 v144, v148, v156, 0
    v_dot2_f32_bf16 v145, v150, v156, 0
    v_perm_b32 v149, v79, v75, s62
    v_perm_b32 v151, v79, v75, s63
    v_dot2_f32_bf16 v146, v149, v156, 0
    v_dot2_f32_bf16 v147, v151, v156, 0
    s_waitcnt vmcnt(12)
    v_perm_b32 v148, v84, v80, s62
    v_perm_b32 v150, v84, v80, s63
    v_dot2_f32_bf16 v140, v148, v157, v140
    v_dot2_f32_bf16 v141, v150, v157, v141
    v_perm_b32 v149, v85, v81, s62
    v_perm_b32 v151, v85, v81, s63
    v_dot2_f32_bf16 v142, v149, v157, v142
    v_dot2_f32_bf16 v143, v151, v157, v143
    v_perm_b32 v148, v86, v82, s62
    v_perm_b32 v150, v86, v82, s63
    v_dot2_f32_bf16 v144, v148, v157, v144
    v_dot2_f32_bf16 v145, v150, v157, v145
    v_perm_b32 v149, v87, v83, s62
    v_perm_b32 v151, v87, v83, s63
    v_dot2_f32_bf16 v146, v149, v157, v146
    v_dot2_f32_bf16 v147, v151, v157, v147
    s_waitcnt vmcnt(10)
    v_perm_b32 v148, v92, v88, s62
    v_perm_b32 v150, v92, v88, s63
    v_dot2_f32_bf16 v140, v148, v158, v140
    v_dot2_f32_bf16 v141, v150, v158, v141
    v_perm_b32 v149, v93, v89, s62
    v_perm_b32 v151, v93, v89, s63
    v_dot2_f32_bf16 v142, v149, v158, v142
    v_dot2_f32_bf16 v143, v151, v158, v143
    v_perm_b32 v148, v94, v90, s62
    v_perm_b32 v150, v94, v90, s63
    v_dot2_f32_bf16 v144, v148, v158, v144
    v_dot2_f32_bf16 v145, v150, v158, v145
    v_perm_b32 v149, v95, v91, s62
    v_perm_b32 v151, v95, v91, s63
    v_dot2_f32_bf16 v146, v149, v158, v146
    v_dot2_f32_bf16 v147, v151, v158, v147
    s_waitcnt vmcnt(8)
    v_perm_b32 v148, v100, v96, s62
    v_perm_b32 v150, v100, v96, s63
    v_dot2_f32_bf16 v140, v148, v159, v140
    v_dot2_f32_bf16 v141, v150, v159, v141
    v_perm_b32 v149, v101, v97, s62
    v_perm_b32 v151, v101, v97, s63
    v_dot2_f32_bf16 v142, v149, v159, v142
    v_dot2_f32_bf16 v143, v151, v159, v143
    v_perm_b32 v148, v102, v98, s62
    v_perm_b32 v150, v102, v98, s63
    v_dot2_f32_bf16 v144, v148, v159, v144
    v_dot2_f32_bf16 v145, v150, v159, v145
    v_perm_b32 v149, v103, v99, s62
    v_perm_b32 v151, v103, v99, s63
    v_dot2_f32_bf16 v146, v149, v159, v146
    v_dot2_f32_bf16 v147, v151, v159, v147
    s_mov_b32 s5, 0
Lspin_88:
    ds_read_b32 v7, v2 offset:4
    s_waitcnt lgkmcnt(0)
    v_readfirstlane_b32 s6, v7
    s_cmp_ge_u32 s6, 1
    s_cbranch_scc1 Lok_89
    s_sleep 1
    s_add_u32 s5, s5, 1
    s_cmp_lt_u32 s5, 1600000
    s_cbranch_scc1 Lspin_88
Lok_89:
    s_sub_u32 s100, s6, 1
    ds_read_b32 v6, v2 offset:128
    s_waitcnt lgkmcnt(0)
    v_sub_f32 v4, v4, v6
    v_mul_f32 v4, 1069066811, v4
    v_exp_f32 v136, v4

    s_mov_b32 s5, 0
Lspin_90:
    ds_read_b32 v7, v2 offset:40
    s_waitcnt lgkmcnt(0)
    v_readfirstlane_b32 s6, v7
    s_cmp_ge_u32 s6, 8
    s_cbranch_scc1 Lok_91
    s_sleep 1
    s_add_u32 s5, s5, 1
    s_cmp_lt_u32 s5, 1600000
    s_cbranch_scc1 Lspin_90
Lok_91:
    s_waitcnt vmcnt(6)
    s_add_u32 s4, s28, 0
    buffer_load_dwordx4 v[8:11], v167, s[20:23], s4 offen nt
    s_add_u32 s4, s28, 1280
    buffer_load_dwordx4 v[12:15], v167, s[20:23], s4 offen nt
    s_add_u32 s4, s28, 20480
    buffer_load_dwordx4 v[16:19], v167, s[20:23], s4 offen nt
    s_add_u32 s4, s28, 21760
    buffer_load_dwordx4 v[20:23], v167, s[20:23], s4 offen nt
    v_perm_b32 v148, v108, v104, s62
    v_perm_b32 v150, v108, v104, s63
    v_dot2_f32_bf16 v140, v148, v160, v140
    v_dot2_f32_bf16 v141, v150, v160, v141
    v_perm_b32 v149, v109, v105, s62
    v_perm_b32 v151, v109, v105, s63
    v_dot2_f32_bf16 v142, v149, v160, v142
    v_dot2_f32_bf16 v143, v151, v160, v143
    v_perm_b32 v148, v110, v106, s62
    v_perm_b32 v150, v110, v106, s63
    v_dot2_f32_bf16 v144, v148, v160, v144
    v_dot2_f32_bf16 v145, v150, v160, v145
    v_perm_b32 v149, v111, v107, s62
    v_perm_b32 v151, v111, v107, s63
    v_dot2_f32_bf16 v146, v149, v160, v146
    v_dot2_f32_bf16 v147, v151, v160, v147
    s_waitcnt vmcnt(8)
    v_perm_b32 v148, v116, v112, s62
    v_perm_b32 v150, v116, v112, s63
    v_dot2_f32_bf16 v140, v148, v161, v140
    v_dot2_f32_bf16 v141, v150, v161, v141
    v_perm_b32 v149, v117, v113, s62
    v_perm_b32 v151, v117, v113, s63
    v_dot2_f32_bf16 v142, v149, v161, v142
    v_dot2_f32_bf16 v143, v151, v161, v143
    v_perm_b32 v148, v118, v114, s62
    v_perm_b32 v150, v118, v114, s63
    v_dot2_f32_bf16 v144, v148, v161, v144
    v_dot2_f32_bf16 v145, v150, v161, v145
    v_perm_b32 v149, v119, v115, s62
    v_perm_b32 v151, v119, v115, s63
    v_dot2_f32_bf16 v146, v149, v161, v146
    v_dot2_f32_bf16 v147, v151, v161, v147
    s_waitcnt vmcnt(6)
    v_perm_b32 v148, v124, v120, s62
    v_perm_b32 v150, v124, v120, s63
    v_dot2_f32_bf16 v140, v148, v162, v140
    v_dot2_f32_bf16 v141, v150, v162, v141
    v_perm_b32 v149, v125, v121, s62
    v_perm_b32 v151, v125, v121, s63
    v_dot2_f32_bf16 v142, v149, v162, v142
    v_dot2_f32_bf16 v143, v151, v162, v143
    v_perm_b32 v148, v126, v122, s62
    v_perm_b32 v150, v126, v122, s63
    v_dot2_f32_bf16 v144, v148, v162, v144
    v_dot2_f32_bf16 v145, v150, v162, v145
    v_perm_b32 v149, v127, v123, s62
    v_perm_b32 v151, v127, v123, s63
    v_dot2_f32_bf16 v146, v149, v162, v146
    v_dot2_f32_bf16 v147, v151, v162, v147
    s_waitcnt vmcnt(4)
    buffer_load_dwordx4 v[24:27], v60, s[8:11], s26 offen offset:0 sc1
    buffer_load_dwordx4 v[28:31], v60, s[8:11], s26 offen offset:64 sc1
    v_perm_b32 v148, v132, v128, s62
    v_perm_b32 v150, v132, v128, s63
    v_dot2_f32_bf16 v140, v148, v163, v140
    v_dot2_f32_bf16 v141, v150, v163, v141
    v_perm_b32 v149, v133, v129, s62
    v_perm_b32 v151, v133, v129, s63
    v_dot2_f32_bf16 v142, v149, v163, v142
    v_dot2_f32_bf16 v143, v151, v163, v143
    v_perm_b32 v148, v134, v130, s62
    v_perm_b32 v150, v134, v130, s63
    v_dot2_f32_bf16 v144, v148, v163, v144
    v_dot2_f32_bf16 v145, v150, v163, v145
    v_perm_b32 v149, v135, v131, s62
    v_perm_b32 v151, v135, v131, s63
    v_dot2_f32_bf16 v146, v149, v163, v146
    v_dot2_f32_bf16 v147, v151, v163, v147
    s_nop 2
    v_permlane32_swap_b32 v140, v144
    v_permlane32_swap_b32 v141, v145
    v_permlane32_swap_b32 v142, v146
    v_permlane32_swap_b32 v143, v147
    v_add_f32 v140, v140, v144
    v_add_f32 v141, v141, v145
    v_add_f32 v142, v142, v146
    v_add_f32 v143, v143, v147
    s_nop 0
    v_permlane16_swap_b32 v140, v142
    v_permlane16_swap_b32 v141, v143
    s_nop 0
    v_add_f32 v140, v140, v142
    v_add_f32 v141, v141, v143
    v_mul_f32 v140, v140, v136
    v_mul_f32 v141, v141, v136
    ds_write_b64 v165, v[140:141] offset:8192
    s_mov_b64 exec, 1
    ds_add_rtn_u32 v4, v2, v3 offset:28
    s_mov_b64 exec, -1
    s_waitcnt lgkmcnt(0)
    v_readfirstlane_b32 s4, v4
    s_cmp_lg_u32 s4, 7
    s_cbranch_scc1 Lskip_92

    ds_read_b64 v[44:45], v5 offset:8192
    ds_read_b64 v[46:47], v5 offset:8704
    ds_read_b64 v[48:49], v5 offset:9216
    ds_read_b64 v[50:51], v5 offset:9728
    ds_read_b64 v[52:53], v5 offset:10240
    ds_read_b64 v[54:55], v5 offset:10752
    ds_read_b64 v[56:57], v5 offset:11264
    ds_read_b64 v[58:59], v5 offset:11776
    s_waitcnt lgkmcnt(6)
    v_pk_add_f32 v[44:45], v[44:45], v[46:47]
    s_waitcnt lgkmcnt(4)
    v_pk_add_f32 v[48:49], v[48:49], v[50:51]
    s_waitcnt lgkmcnt(2)
    v_pk_add_f32 v[52:53], v[52:53], v[54:55]
    s_waitcnt lgkmcnt(0)
    v_pk_add_f32 v[56:57], v[56:57], v[58:59]
    v_pk_add_f32 v[44:45], v[44:45], v[48:49]
    v_pk_add_f32 v[52:53], v[52:53], v[56:57]
    v_add_f32 v40, v44, v52
    v_add_f32 v42, v45, v53
    buffer_store_dwordx4 v[40:43], v1, s[16:19], s25 offen
    buffer_store_dwordx4 v[40:43], v1, s[16:19], s24 offen sc1
    s_waitcnt vmcnt(2)
    s_branch Lj_93

Lskip_92:
    s_waitcnt vmcnt(0)
Lj_93:
    s_cmp_ge_u32 s101, 20
    s_cbranch_scc1 L_role
    v_perm_b32 v72, v12, v8, s62
    v_perm_b32 v73, v12, v8, s63
    v_perm_b32 v74, v13, v9, s62
    v_perm_b32 v75, v13, v9, s63
    v_perm_b32 v76, v14, v10, s62
    v_perm_b32 v77, v14, v10, s63
    v_perm_b32 v78, v15, v11, s62
    v_perm_b32 v79, v15, v11, s63
    v_perm_b32 v80, v20, v16, s62
    v_perm_b32 v81, v20, v16, s63
    v_perm_b32 v82, v21, v17, s62
    v_perm_b32 v83, v21, v17, s63
    v_perm_b32 v84, v22, v18, s62
    v_perm_b32 v85, v22, v18, s63
    v_perm_b32 v86, v23, v19, s62
    v_perm_b32 v87, v23, v19, s63
    v_and_b32 v6, 7, v0
    v_lshlrev_b32 v6, 3, v6
    v_lshrrev_b32 v7, 5, v0
    v_lshl_add_u32 v6, v7, 2, v6
    v_bfe_u32 v7, v0, 4, 1
    v_lshl_add_u32 v6, v7, 1, v6

    s_lshl_b32 s4, s3, 8
    v_lshl_add_u32 v6, v6, 2, s4
    s_cmp_ge_u32 s101, 10
    s_cselect_b32 s6, 1, 0
    s_and_b32 s4, s2, 7
    s_lshl_b32 s4, s4, 1
    s_add_u32 s4, s4, s6
    s_mul_i32 s24, s4, 2560
    s_mul_i32 s7, s6, 10
    s_sub_u32 s7, s101, s7
    s_lshl_b32 s7, s7, 8
    s_add_u32 s24, s24, s7
    s_add_u32 s24, s24, 655360
    v_lshrrev_b32 v7, 3, v0
    v_lshlrev_b32 v7, 2, v7
    s_add_u32 s28, s29, 4096

    v_min3_u32 v8, v25, v27, v29
    v_min_u32 v8, v8, v31
    v_max3_u32 v9, v25, v27, v29
    v_max_u32 v9, v9, v31
    v_cmp_ne_u32 s[30:31], s32, v8
    v_cmp_ne_u32 s[6:7], s32, v9
    s_or_b64 s[30:31], s[30:31], s[6:7]
    s_cmp_eq_u64 s[30:31], 0
    s_cbranch_scc1 Lml_94
    s_mov_b32 s5, s100
Lpoll_95:
    buffer_load_dwordx4 v[24:27], v60, s[8:11], s26 offen offset:0 sc1
    buffer_load_dwordx4 v[28:31], v60, s[8:11], s26 offen offset:64 sc1
    s_waitcnt vmcnt(0)
    v_min3_u32 v8, v25, v27, v29
    v_min_u32 v8, v8, v31
    v_max3_u32 v9, v25, v27, v29
    v_max_u32 v9, v9, v31
    v_cmp_ne_u32 s[30:31], s32, v8
    v_cmp_ne_u32 s[6:7], s32, v9
    s_or_b64 s[30:31], s[30:31], s[6:7]
    s_cmp_eq_u64 s[30:31], 0
    s_cbranch_scc1 Lok_96
    s_add_u32 s5, s5, 1
    s_cmp_ge_u32 s5, 64
    s_cselect_b32 s4, s5, 0
    s_and_b32 s4, s4, 1
    s_xor_b32 s4, s4, 1
    s_lshl_b32 s4, s4, 22
    s_add_u32 s8, s60, s4
    s_addc_u32 s9, s61, 0
    s_cmp_lt_u32 s5, 400000
    s_cbranch_scc1 Lpoll_95

Lok_96:
    s_add_u32 s8, s60, 4194304
    s_addc_u32 s9, s61, 0
    s_mov_b32 s10, 532676608
    s_mov_b32 s11, 0x00020000

Lml_94:
    buffer_load_dwordx4 v[8:11], v166, s[8:11], s29 offen sc1
    buffer_load_dwordx4 v[12:15], v166, s[8:11], s28 offen sc1
    v_max_f32 v68, v24, v28
    v_mov_b32 v69, v68
    s_nop 1
    v_permlane16_swap_b32 v68, v69
    s_nop 0
    v_max_f32 v68, v68, v69
    v_mov_b32 v69, v68
    s_nop 1
    v_permlane32_swap_b32 v68, v69
    s_nop 0
    v_max_f32 v68, v68, v69
    v_sub_f32 v64, v24, v68
    v_sub_f32 v65, v28, v68
    v_mul_f32 v64, 1069066811, v64
    v_mul_f32 v65, 1069066811, v65
    v_exp_f32 v64, v64
    v_exp_f32 v65, v65
    s_nop 0
    v_mul_f32 v68, v64, v26
    v_fmac_f32 v68, v65, v30

    v_mov_b32 v69, v68
    s_nop 1
    v_permlane16_swap_b32 v68, v69
    s_nop 0
    v_add_f32 v68, v68, v69
    v_mov_b32 v69, v68
    s_nop 1
    v_permlane32_swap_b32 v68, v69
    s_nop 0
    v_add_f32 v68, v68, v69
    v_rcp_f32 v68, v68
    s_nop 0
    v_mul_f32 v64, v64, v68
    v_mul_f32 v65, v65, v68

    s_waitcnt vmcnt(0)
    v_min3_u32 v24, v9, v11, v13
    v_min_u32 v24, v24, v15
    v_max3_u32 v25, v9, v11, v13
    v_max_u32 v25, v25, v15
    v_cmp_ne_u32 s[30:31], s32, v24
    v_cmp_ne_u32 s[6:7], s32, v25
    s_or_b64 s[30:31], s[30:31], s[6:7]
    s_cmp_eq_u64 s[30:31], 0
    s_cbranch_scc1 Lo_97
    s_mov_b32 s5, s100
Lpoll_98:
    buffer_load_dwordx4 v[8:11], v166, s[8:11], s29 offen sc1
    buffer_load_dwordx4 v[12:15], v166, s[8:11], s28 offen sc1
    s_waitcnt vmcnt(0)
    v_min3_u32 v24, v9, v11, v13
    v_min_u32 v24, v24, v15
    v_max3_u32 v25, v9, v11, v13
    v_max_u32 v25, v25, v15
    v_cmp_ne_u32 s[30:31], s32, v24
    v_cmp_ne_u32 s[6:7], s32, v25
    s_or_b64 s[30:31], s[30:31], s[6:7]
    s_cmp_eq_u64 s[30:31], 0
    s_cbranch_scc1 Lok_99
    s_add_u32 s5, s5, 1
    s_cmp_ge_u32 s5, 64
    s_cselect_b32 s4, s5, 0
    s_and_b32 s4, s4, 1
    s_xor_b32 s4, s4, 1
    s_lshl_b32 s4, s4, 22
    s_add_u32 s8, s60, s4
    s_addc_u32 s9, s61, 0
    s_cmp_lt_u32 s5, 400000
    s_cbranch_scc1 Lpoll_98

Lok_99:
Lo_97:
    v_mul_f32 v24, v8, v64
    v_mul_f32 v25, v10, v64
    v_fmac_f32 v24, v12, v65
    v_fmac_f32 v25, v14, v65
    s_nop 1
    v_permlane32_swap_b32 v24, v25
    s_nop 0
    v_add_f32 v24, v24, v25
    v_mov_b32 v25, v24
    s_nop 1
    v_permlane16_swap_b32 v24, v25
    s_nop 0
    v_add_f32 v24, v24, v25
    v_mov_b32 v25, v24
    s_nop 1
    v_permlane32_swap_b32 v24, v25
    s_nop 0
    v_cvt_pk_bf16_f32 v24, v24, v25
    s_nop 0
    ds_bpermute_b32 v8, v7, v24
    ds_bpermute_b32 v9, v7, v24 offset:32

    s_waitcnt lgkmcnt(1)
    v_dot2_f32_bf16 v140, v72, v8, 0
    v_dot2_f32_bf16 v141, v73, v8, 0
    v_dot2_f32_bf16 v142, v74, v8, 0
    v_dot2_f32_bf16 v143, v75, v8, 0
    v_dot2_f32_bf16 v144, v76, v8, 0
    v_dot2_f32_bf16 v145, v77, v8, 0
    v_dot2_f32_bf16 v146, v78, v8, 0
    v_dot2_f32_bf16 v147, v79, v8, 0
    s_waitcnt lgkmcnt(0)
    v_dot2_f32_bf16 v140, v80, v9, v140
    v_dot2_f32_bf16 v141, v81, v9, v141
    v_dot2_f32_bf16 v142, v82, v9, v142
    v_dot2_f32_bf16 v143, v83, v9, v143
    v_dot2_f32_bf16 v144, v84, v9, v144
    v_dot2_f32_bf16 v145, v85, v9, v145
    v_dot2_f32_bf16 v146, v86, v9, v146
    v_dot2_f32_bf16 v147, v87, v9, v147
    s_nop 2
    v_permlane32_swap_b32 v140, v144
    v_permlane32_swap_b32 v141, v145
    v_permlane32_swap_b32 v142, v146
    v_permlane32_swap_b32 v143, v147
    v_add_f32 v140, v140, v144
    v_add_f32 v141, v141, v145
    v_add_f32 v142, v142, v146
    v_add_f32 v143, v143, v147
    s_nop 0
    v_permlane16_swap_b32 v140, v142
    v_permlane16_swap_b32 v141, v143
    s_nop 0
    v_add_f32 v140, v140, v142
    v_add_f32 v141, v141, v143
    s_nop 0
    s_nop 0
    v_add_f32_dpp v140, v140, v140 row_ror:8 row_mask:0xf bank_mask:0xf
    v_add_f32_dpp v141, v141, v141 row_ror:8 row_mask:0xf bank_mask:0xf
    s_nop 0
    ds_write_b64 v6, v[140:141] offset:12288
    s_mov_b64 exec, 1
    ds_add_rtn_u32 v4, v2, v3 offset:32
    s_mov_b64 exec, -1
    s_waitcnt lgkmcnt(0)
    v_readfirstlane_b32 s4, v4
    s_cmp_lg_u32 s4, 7
    s_cbranch_scc1 Lskip_100

    ds_read_b64 v[44:45], v5 offset:12288
    ds_read_b64 v[46:47], v5 offset:12544
    ds_read_b64 v[48:49], v5 offset:12800
    ds_read_b64 v[50:51], v5 offset:13056
    ds_read_b64 v[52:53], v5 offset:13312
    ds_read_b64 v[54:55], v5 offset:13568
    ds_read_b64 v[56:57], v5 offset:13824
    ds_read_b64 v[58:59], v5 offset:14080
    s_waitcnt lgkmcnt(6)
    v_pk_add_f32 v[44:45], v[44:45], v[46:47]
    s_waitcnt lgkmcnt(4)
    v_pk_add_f32 v[48:49], v[48:49], v[50:51]
    s_waitcnt lgkmcnt(2)
    v_pk_add_f32 v[52:53], v[52:53], v[54:55]
    s_waitcnt lgkmcnt(0)
    v_pk_add_f32 v[56:57], v[56:57], v[58:59]
    v_pk_add_f32 v[44:45], v[44:45], v[48:49]
    v_pk_add_f32 v[52:53], v[52:53], v[56:57]
    v_add_f32 v40, v44, v52
    v_add_f32 v42, v45, v53
    v_cvt_pk_bf16_f32 v40, v40, v42
    s_mov_b32 exec_hi, 0
    buffer_store_dwordx2 v[40:41], v5, s[16:19], s24 offen sc1
    s_mov_b64 exec, -1

Lskip_100:
    s_cmp_lg_u32 s3, 0
    s_cbranch_scc1 L_sexit
    s_branch L_sexit
L_role:
    s_cmp_lt_u32 s35, 54
    s_cbranch_scc1 L_mlp
    s_cmp_ge_u32 s3, 2
    s_cbranch_scc1 L_sexit
    s_sub_u32 s35, s35, 54
    s_cmp_ge_u32 s35, 20
    s_cbranch_scc1 L_sexit
    s_lshl_b32 s35, s35, 1
    s_add_u32 s35, s35, s3
    s_branch L_red

L_qk:
    s_mul_i32 s32, s32, 0x9e3779b1
    s_add_u32 s32, s32, 0x7f4a7c15
    s_mov_b32 s100, 99
    v_and_b32 v3, 15, v0
    v_lshlrev_b32 v3, 4, v3
    ds_read_b128 v[136:139], v3 offset:256
    v_and_b32 v3, 3, v0
    v_cmp_eq_u32 s[6:7], 1, v3
    v_cmp_eq_u32 s[30:31], 2, v3
    v_cmp_eq_u32 vcc, 3, v3
    s_waitcnt lgkmcnt(0)
    v_dot2_f32_bf16 v140, v8, v136, 0
    v_dot2_f32_bf16 v141, v12, v136, 0
    v_dot2_f32_bf16 v142, v16, v136, 0
    v_dot2_f32_bf16 v143, v20, v136, 0
    v_dot2_f32_bf16 v144, v24, v136, 0
    v_dot2_f32_bf16 v145, v28, v136, 0
    v_dot2_f32_bf16 v146, v32, v136, 0
    v_dot2_f32_bf16 v147, v36, v136, 0
    v_dot2_f32_bf16 v148, v40, v136, 0
    v_dot2_f32_bf16 v149, v44, v136, 0
    v_dot2_f32_bf16 v150, v48, v136, 0
    v_dot2_f32_bf16 v151, v52, v136, 0
    v_dot2_f32_bf16 v152, v56, v136, 0
    v_dot2_f32_bf16 v153, v60, v136, 0
    v_dot2_f32_bf16 v154, v64, v136, 0
    v_dot2_f32_bf16 v155, v68, v136, 0
    v_dot2_f32_bf16 v140, v9, v137, v140
    v_dot2_f32_bf16 v141, v13, v137, v141
    v_dot2_f32_bf16 v142, v17, v137, v142
    v_dot2_f32_bf16 v143, v21, v137, v143
    v_dot2_f32_bf16 v144, v25, v137, v144
    v_dot2_f32_bf16 v145, v29, v137, v145
    v_dot2_f32_bf16 v146, v33, v137, v146
    v_dot2_f32_bf16 v147, v37, v137, v147
    v_dot2_f32_bf16 v148, v41, v137, v148
    v_dot2_f32_bf16 v149, v45, v137, v149
    v_dot2_f32_bf16 v150, v49, v137, v150
    v_dot2_f32_bf16 v151, v53, v137, v151
    v_dot2_f32_bf16 v152, v57, v137, v152
    v_dot2_f32_bf16 v153, v61, v137, v153
    v_dot2_f32_bf16 v154, v65, v137, v154
    v_dot2_f32_bf16 v155, v69, v137, v155
    v_dot2_f32_bf16 v140, v10, v138, v140
    v_dot2_f32_bf16 v141, v14, v138, v141
    v_dot2_f32_bf16 v142, v18, v138, v142
    v_dot2_f32_bf16 v143, v22, v138, v143
    v_dot2_f32_bf16 v144, v26, v138, v144
    v_dot2_f32_bf16 v145, v30, v138, v145
    v_dot2_f32_bf16 v146, v34, v138, v146
    v_dot2_f32_bf16 v147, v38, v138, v147
    v_dot2_f32_bf16 v148, v42, v138, v148
    v_dot2_f32_bf16 v149, v46, v138, v149
    v_dot2_f32_bf16 v150, v50, v138, v150
    v_dot2_f32_bf16 v151, v54, v138, v151
    v_dot2_f32_bf16 v152, v58, v138, v152
    v_dot2_f32_bf16 v153, v62, v138, v153
    v_dot2_f32_bf16 v154, v66, v138, v154
    v_dot2_f32_bf16 v155, v70, v138, v155
    v_dot2_f32_bf16 v140, v11, v139, v140
    v_dot2_f32_bf16 v141, v15, v139, v141
    v_dot2_f32_bf16 v142, v19, v139, v142
    v_dot2_f32_bf16 v143, v23, v139, v143
    v_dot2_f32_bf16 v144, v27, v139, v144
    v_dot2_f32_bf16 v145, v31, v139, v145
    v_dot2_f32_bf16 v146, v35, v139, v146
    v_dot2_f32_bf16 v147, v39, v139, v147
    v_dot2_f32_bf16 v148, v43, v139, v148
    v_dot2_f32_bf16 v149, v47, v139, v149
    v_dot2_f32_bf16 v150, v51, v139, v150
    v_dot2_f32_bf16 v151, v55, v139, v151
    v_dot2_f32_bf16 v152, v59, v139, v152
    v_dot2_f32_bf16 v153, v63, v139, v153
    v_dot2_f32_bf16 v154, v67, v139, v154
    v_dot2_f32_bf16 v155, v71, v139, v155
    s_nop 2
    v_add_f32_dpp v140, v140, v140 row_ror:8 row_mask:0xf bank_mask:0x3
    v_add_f32_dpp v141, v141, v141 row_ror:8 row_mask:0xf bank_mask:0x3
    v_add_f32_dpp v142, v142, v142 row_ror:8 row_mask:0xf bank_mask:0x3
    v_add_f32_dpp v143, v143, v143 row_ror:8 row_mask:0xf bank_mask:0x3
    v_add_f32_dpp v144, v144, v144 row_ror:8 row_mask:0xf bank_mask:0x3
    v_add_f32_dpp v145, v145, v145 row_ror:8 row_mask:0xf bank_mask:0x3
    v_add_f32_dpp v146, v146, v146 row_ror:8 row_mask:0xf bank_mask:0x3
    v_add_f32_dpp v147, v147, v147 row_ror:8 row_mask:0xf bank_mask:0x3
    v_add_f32_dpp v140, v148, v148 row_ror:8 row_mask:0xf bank_mask:0xc
    v_add_f32_dpp v141, v149, v149 row_ror:8 row_mask:0xf bank_mask:0xc
    v_add_f32_dpp v142, v150, v150 row_ror:8 row_mask:0xf bank_mask:0xc
    v_add_f32_dpp v143, v151, v151 row_ror:8 row_mask:0xf bank_mask:0xc
    v_add_f32_dpp v144, v152, v152 row_ror:8 row_mask:0xf bank_mask:0xc
    v_add_f32_dpp v145, v153, v153 row_ror:8 row_mask:0xf bank_mask:0xc
    v_add_f32_dpp v146, v154, v154 row_ror:8 row_mask:0xf bank_mask:0xc
    v_add_f32_dpp v147, v155, v155 row_ror:8 row_mask:0xf bank_mask:0xc
    v_add_f32_dpp v140, v140, v140 row_half_mirror row_mask:0xf bank_mask:0x5
    v_add_f32_dpp v141, v141, v141 row_half_mirror row_mask:0xf bank_mask:0x5
    v_add_f32_dpp v142, v142, v142 row_half_mirror row_mask:0xf bank_mask:0x5
    v_add_f32_dpp v143, v143, v143 row_half_mirror row_mask:0xf bank_mask:0x5
    v_add_f32_dpp v140, v144, v144 row_half_mirror row_mask:0xf bank_mask:0xa
    v_add_f32_dpp v141, v145, v145 row_half_mirror row_mask:0xf bank_mask:0xa
    v_add_f32_dpp v142, v146, v146 row_half_mirror row_mask:0xf bank_mask:0xa
    v_add_f32_dpp v143, v147, v147 row_half_mirror row_mask:0xf bank_mask:0xa
    v_add_f32_dpp v140, v140, v140 quad_perm:[1,0,3,2] row_mask:0xf bank_mask:0xf
    v_add_f32_dpp v141, v141, v141 quad_perm:[1,0,3,2] row_mask:0xf bank_mask:0xf
    v_add_f32_dpp v142, v142, v142 quad_perm:[1,0,3,2] row_mask:0xf bank_mask:0xf
    v_add_f32_dpp v143, v143, v143 quad_perm:[1,0,3,2] row_mask:0xf bank_mask:0xf
    v_add_f32_dpp v140, v140, v140 quad_perm:[2,3,0,1] row_mask:0xf bank_mask:0xf
    v_add_f32_dpp v141, v141, v141 quad_perm:[2,3,0,1] row_mask:0xf bank_mask:0xf
    v_add_f32_dpp v142, v142, v142 quad_perm:[2,3,0,1] row_mask:0xf bank_mask:0xf
    v_add_f32_dpp v143, v143, v143 quad_perm:[2,3,0,1] row_mask:0xf bank_mask:0xf
    v_cndmask_b32 v140, v140, v141, s[6:7]
    v_cndmask_b32 v140, v140, v142, s[30:31]
    v_cndmask_b32 v140, v140, v143, vcc

    v_cvt_pk_bf16_f32 v140, v140, v140
    v_and_b32 v140, 0xffff0000, v140
    v_mul_f32 v140, 1035273459, v140
    v_cvt_pk_bf16_f32 v140, v140, v140
    v_and_b32 v140, 0xffff0000, v140
    v_mov_b32 v4, v140
    s_nop 0
    s_nop 1
    v_max_f32_dpp v4, v4, v4 row_ror:8 row_mask:0xf bank_mask:0xf
    s_nop 1
    v_max_f32_dpp v4, v4, v4 row_ror:4 row_mask:0xf bank_mask:0xf
    s_nop 1
    v_max_f32_dpp v4, v4, v4 row_ror:2 row_mask:0xf bank_mask:0xf
    s_nop 1
    v_max_f32_dpp v4, v4, v4 row_ror:1 row_mask:0xf bank_mask:0xf
    v_mov_b32 v5, v4
    s_nop 1
    v_permlane16_swap_b32 v4, v5
    s_nop 0
    v_max_f32 v4, v4, v5
    v_mov_b32 v5, v4
    s_nop 1
    v_permlane32_swap_b32 v4, v5
    s_nop 0
    v_max_f32 v4, v4, v5
    v_sub_f32 v140, v140, v4
    v_mul_f32 v140, 1069066811, v140
    v_exp_f32 v140, v140
    s_nop 0
    v_mov_b32 v5, v140
    s_nop 0
    v_mov_b32_dpp v141, v140 quad_perm:[1,0,3,2] row_mask:0xf bank_mask:0xf

    s_nop 0
    s_nop 1
    v_add_f32_dpp v5, v5, v5 row_ror:8 row_mask:0xf bank_mask:0xf
    s_nop 1
    v_add_f32_dpp v5, v5, v5 row_ror:4 row_mask:0xf bank_mask:0xf
    s_nop 1
    v_add_f32_dpp v5, v5, v5 row_ror:2 row_mask:0xf bank_mask:0xf
    s_nop 1
    v_add_f32_dpp v5, v5, v5 row_ror:1 row_mask:0xf bank_mask:0xf
    v_cvt_pk_bf16_f32 v141, v140, v141
    v_mov_b32 v6, v5
    s_nop 1
    v_permlane16_swap_b32 v5, v6
    s_nop 0
    v_add_f32 v5, v5, v6
    v_mov_b32 v6, v5
    s_nop 1
    v_permlane32_swap_b32 v5, v6
    s_nop 0
    v_add_f32 v5, v5, v6
    v_mov_b32_dpp v156, v141 row_newbcast:0 row_mask:0xf bank_mask:0xf
    v_mov_b32_dpp v157, v141 row_newbcast:2 row_mask:0xf bank_mask:0xf
    v_mov_b32_dpp v158, v141 row_newbcast:4 row_mask:0xf bank_mask:0xf
    v_mov_b32_dpp v159, v141 row_newbcast:6 row_mask:0xf bank_mask:0xf
    v_mov_b32_dpp v160, v141 row_newbcast:8 row_mask:0xf bank_mask:0xf
    v_mov_b32_dpp v161, v141 row_newbcast:10 row_mask:0xf bank_mask:0xf
    v_mov_b32_dpp v162, v141 row_newbcast:12 row_mask:0xf bank_mask:0xf
    v_mov_b32_dpp v163, v141 row_newbcast:14 row_mask:0xf bank_mask:0xf
    s_lshl_b32 s4, s3, 3
    v_mov_b32 v3, s4
    ds_write_b64 v3, v[4:5] offset:64
    v_mov_b32 v3, 1
    s_mov_b64 exec, 1
    ds_add_u32 v2, v3 offset:8
    s_mov_b64 exec, -1
    s_setpc_b64 s[98:99]
L_red:
    s_mov_b32 s5, 0
Lspin_101:
    ds_read_b32 v4, v2 offset:12
    s_waitcnt lgkmcnt(0)
    v_readfirstlane_b32 s6, v4
    s_cmp_ge_u32 s6, 1
    s_cbranch_scc1 Lok_102
    s_sleep 1
    s_add_u32 s5, s5, 1
    s_cmp_lt_u32 s5, 1600000
    s_cbranch_scc1 Lspin_101
Lok_102:
    s_mov_b32 s20, s56
    s_mov_b32 s21, s57
    s_mov_b32 s22, 1280
    s_mov_b32 s23, 0x00020000

    v_and_b32 v5, 7, v0
    s_lshl_b32 s4, s3, 6
    v_lshl_add_u32 v6, v5, 3, s4
    ds_read_b64 v[72:73], v6 offset:1408
    ds_read_b64 v[74:75], v6 offset:1536
    ds_read_b64 v[76:77], v6 offset:1664
    v_lshrrev_b32 v6, 3, v0
    v_mul_u32_u24 v6, 2560, v6
    v_lshl_add_u32 v6, v5, 3, v6
    s_lshl_b32 s26, s35, 6
    s_add_u32 s26, s26, 655360
    s_mul_i32 s24, s35, 6912
    s_add_u32 s24, s24, 706560
    s_mov_b32 s96, -1
    s_mov_b32 s97, 0xffff
    v_mov_b32 v4, 2147483392
    v_lshlrev_b32 v7, 2, v0
    v_cndmask_b32 v4, v4, v1, s[96:97]
    s_lshl_b32 s27, s35, 5
    s_waitcnt vmcnt(0) lgkmcnt(0)

    s_add_u32 s25, s26, 20480
    s_mov_b32 s5, 0
Lpoll_103:
    buffer_load_dwordx2 v[12:13], v6, s[16:19], s26 offen sc1
    buffer_load_dwordx2 v[14:15], v6, s[16:19], s25 offen sc1
    s_waitcnt vmcnt(0)
    v_cmp_ne_u32 s[30:31], s32, v13
    v_cmp_ne_u32 s[6:7], s32, v15
    s_or_b64 s[30:31], s[30:31], s[6:7]
    s_cmp_eq_u64 s[30:31], 0
    s_cbranch_scc1 Lok_104
    s_sleep 1
    s_add_u32 s5, s5, 1
    s_cmp_lt_u32 s5, 400000
    s_cbranch_scc1 Lpoll_103
Lok_104:
    v_lshlrev_b32 v8, 16, v12
    v_and_b32 v10, 0xffff0000, v12
    v_lshlrev_b32 v9, 16, v14
    v_and_b32 v11, 0xffff0000, v14
    v_add_f32 v8, v8, v9
    v_add_f32 v10, v10, v11

    s_nop 0
    s_nop 0
    v_add_f32_dpp v8, v8, v8 row_ror:8 row_mask:0xf bank_mask:0xf
    v_add_f32_dpp v10, v10, v10 row_ror:8 row_mask:0xf bank_mask:0xf
    v_mov_b32 v12, v8
    v_mov_b32 v13, v10
    s_nop 1
    v_permlane16_swap_b32 v8, v12
    v_permlane16_swap_b32 v10, v13
    s_nop 0
    v_add_f32 v8, v8, v12
    v_add_f32 v10, v10, v13
    v_mov_b32 v12, v8
    v_mov_b32 v13, v10
    s_nop 1
    v_permlane32_swap_b32 v8, v12
    v_permlane32_swap_b32 v10, v13
    s_nop 0
    v_add_f32 v8, v8, v12
    v_add_f32 v10, v10, v13
    v_fma_f32 v80, v8, v72, v76
    v_fma_f32 v82, v10, v73, v77
    v_cvt_pk_bf16_f32 v12, v80, v82
    v_lshlrev_b32 v80, 16, v12
    v_and_b32 v82, 0xffff0000, v12
    s_mov_b32 s5, 0
Lpoll_105:
    s_add_u32 s25, s24, 0
    buffer_load_dwordx4 v[84:87], v1, s[16:19], s25 offen offset:0 sc1
    buffer_load_dwordx4 v[88:91], v1, s[16:19], s25 offen offset:1024 sc1
    buffer_load_dwordx4 v[92:95], v1, s[16:19], s25 offen offset:2048 sc1
    buffer_load_dwordx4 v[96:99], v1, s[16:19], s25 offen offset:3072 sc1
    s_add_u32 s25, s24, 4096
    buffer_load_dwordx4 v[100:103], v1, s[16:19], s25 offen offset:0 sc1
    buffer_load_dwordx4 v[104:107], v1, s[16:19], s25 offen offset:1024 sc1
    buffer_load_dwordx4 v[16:19], v4, s[16:19], s25 offen offset:2048 sc1
    s_waitcnt vmcnt(0)
    v_min3_u32 v14, v85, v87, v89
    v_min3_u32 v14, v14, v91, v93
    v_min3_u32 v14, v14, v95, v97
    v_min3_u32 v14, v14, v99, v101
    v_min3_u32 v14, v14, v103, v105
    v_min_u32 v14, v14, v107
    v_max3_u32 v15, v85, v87, v89
    v_max3_u32 v15, v15, v91, v93
    v_max3_u32 v15, v15, v95, v97
    v_max3_u32 v15, v15, v99, v101
    v_max3_u32 v15, v15, v103, v105
    v_max_u32 v15, v15, v107
    v_cmp_ne_u32 s[30:31], s32, v14
    v_cmp_ne_u32 s[6:7], s32, v15
    s_or_b64 s[30:31], s[30:31], s[6:7]
    v_cmp_ne_u32 s[6:7], s32, v17
    s_and_b64 s[6:7], s[6:7], s[96:97]
    s_or_b64 s[30:31], s[30:31], s[6:7]
    v_cmp_ne_u32 s[6:7], s32, v19
    s_and_b64 s[6:7], s[6:7], s[96:97]
    s_or_b64 s[30:31], s[30:31], s[6:7]
    s_cmp_eq_u64 s[30:31], 0
    s_cbranch_scc1 Lok_106
    s_add_u32 s5, s5, 1
    s_cmp_lt_u32 s5, 400000
    s_cbranch_scc1 Lpoll_105
Lok_106:
    v_add_f32 v84, v84, v88
    v_add_f32 v86, v86, v90
    v_add_f32 v92, v92, v96
    v_add_f32 v94, v94, v98
    v_add_f32 v100, v100, v104
    v_add_f32 v102, v102, v106
    v_add_f32 v84, v84, v92
    v_add_f32 v86, v86, v94
    v_add_f32 v100, v100, v16
    v_add_f32 v102, v102, v18
    v_add_f32 v84, v84, v100
    v_add_f32 v86, v86, v102
    s_nop 0
    s_nop 0
    v_add_f32_dpp v84, v84, v84 row_ror:8 row_mask:0xf bank_mask:0xf
    v_add_f32_dpp v86, v86, v86 row_ror:8 row_mask:0xf bank_mask:0xf
    v_mov_b32 v12, v84
    v_mov_b32 v13, v86
    s_nop 1
    v_permlane16_swap_b32 v84, v12
    v_permlane16_swap_b32 v86, v13
    s_nop 0
    v_add_f32 v84, v84, v12
    v_add_f32 v86, v86, v13
    v_mov_b32 v12, v84
    v_mov_b32 v13, v86
    s_nop 1
    v_permlane32_swap_b32 v84, v12
    v_permlane32_swap_b32 v86, v13
    s_nop 0
    v_add_f32 v84, v84, v12
    v_add_f32 v86, v86, v13
    v_fma_f32 v8, v84, v74, v80
    v_fma_f32 v10, v86, v75, v82
    v_cvt_pk_bf16_f32 v8, v8, v10
    s_mov_b64 exec, 0xff
    buffer_store_dword v8, v7, s[20:23], s27 offen
    s_mov_b64 exec, -1

    s_cmp_lg_u32 s35, 0
    s_cbranch_scc1 Lskip_107
    v_mov_b32 v8, s32
    s_mov_b64 exec, 1
    buffer_store_dword v8, v2, s[16:19], 0 offen
    s_mov_b64 exec, -1

Lskip_107:
    s_cmp_lg_u32 s3, 0
    s_cbranch_scc1 L_sexit
    s_branch L_sexit
L_mlp:
    s_mov_b32 s12, s36
    s_mov_b32 s13, s37
    s_mov_b32 s14, 1280
    s_mov_b32 s15, 0x00020000

    v_cmp_gt_u32 s[28:29], 40, v0
    v_and_b32 v4, 8, v0
    v_cmp_eq_u32 s[96:97], 0, v4
    s_mul_i32 s4, s3, 160
    v_lshlrev_b32 v4, 2, v0
    buffer_load_dword v156, v4, s[12:15], s4 offen
    s_mul_i32 s4, s3, 320
    v_lshl_add_u32 v160, v0, 3, s4
    v_and_b32 v137, 0xfc, v0
    s_lshl_b32 s4, s3, 3
    v_mov_b32 v138, s4
    s_mul_i32 s21, s3, 320
    s_add_u32 s21, s21, 655360

    v_and_b32 v4, 3, v0
    v_lshlrev_b32 v4, 3, v4
    v_lshrrev_b32 v6, 5, v0
    v_lshl_add_u32 v4, v6, 2, v4
    v_bfe_u32 v6, v0, 4, 1
    v_lshl_add_u32 v4, v6, 1, v4

    s_lshl_b32 s4, s3, 7
    v_lshl_add_u32 v139, v4, 2, s4
    v_and_b32 v4, 7, v0
    v_lshlrev_b32 v4, 7, v4
    v_bfe_u32 v6, v0, 3, 1
    v_lshl_add_u32 v4, v6, 6, v4
    v_lshrrev_b32 v6, 4, v0
    v_lshl_add_u32 v165, v6, 3, v4
    s_mul_i32 s4, s3, 80
    v_add_u32 v4, s4, v164
    v_lshrrev_b32 v5, 4, v4
    v_and_b32 v4, 15, v4
    v_lshlrev_b32 v4, 3, v4
    s_mov_b32 s4, 6912
    v_mul_lo_u32 v5, v5, s4
    v_add_u32 v4, v4, v5
    v_and_b32 v5, 15, v0
    v_cmp_gt_u32 vcc, 10, v5
    v_mov_b32 v7, 2147483392
    s_lshl_b32 s23, s35, 7
    v_cndmask_b32 v166, v7, v4, vcc
    s_add_u32 s23, s23, 706560
    v_min_u32 v5, 9, v5
    v_mul_u32_u24 v6, 2560, v6
    v_lshl_add_u32 v6, v5, 4, v6
    s_mul_i32 s4, s3, 160
    s_add_u32 s4, s4, 69632
    v_add_u32 v167, s4, v6
    v_and_b32 v5, 7, v0
    v_lshlrev_b32 v5, 3, v5
    v_mov_b32 v3, 1

    s_mov_b32 s5, 0
Lspin_108:
    ds_read_b32 v4, v2 offset:12
    s_waitcnt lgkmcnt(0)
    v_readfirstlane_b32 s6, v4
    s_cmp_ge_u32 s6, 1
    s_cbranch_scc1 Lok_109
    s_sleep 1
    s_add_u32 s5, s5, 1
    s_cmp_lt_u32 s5, 1600000
    s_cbranch_scc1 Lspin_108
Lok_109:
    ds_read_b64 v[158:159], v160 offset:4608
    ds_read_b64 v[160:161], v160 offset:2048
    ds_read_b32 v151, v2 offset:136

    s_mov_b32 s5, 0
Lspin_110:
    ds_read_b32 v4, v2 offset:20
    s_waitcnt lgkmcnt(0)
    v_readfirstlane_b32 s6, v4
    s_cmp_ge_u32 s6, 1
    s_cbranch_scc1 Lok_111
    s_sleep 1
    s_add_u32 s5, s5, 1
    s_cmp_lt_u32 s5, 1600000
    s_cbranch_scc1 Lspin_110
Lok_111:
    s_mul_i32 s4, s3, 6144
    v_add_u32 v4, s4, v1
    ds_read_b128 v[8:11], v4 offset:20480
    ds_read_b128 v[12:15], v4 offset:21504
    ds_read_b128 v[16:19], v4 offset:22528
    ds_read_b128 v[20:23], v4 offset:23552
    ds_read_b128 v[24:27], v4 offset:24576
    ds_read_b128 v[28:31], v4 offset:25600
    v_perm_b32 v32, v161, v160, s62
    v_perm_b32 v33, v161, v160, s63
    v_cndmask_b32 v32, 0, v32, s[28:29]
    v_cndmask_b32 v33, 0, v33, s[28:29]
    v_lshlrev_b32 v160, 16, v160
    v_lshlrev_b32 v161, 16, v161
    v_mov_b32 v153, s32
    v_mov_b32 v155, s32
    s_waitcnt lgkmcnt(0)

    v_perm_b32 v88, v12, v8, s62
    v_perm_b32 v89, v12, v8, s63
    v_perm_b32 v90, v13, v9, s62
    v_perm_b32 v91, v13, v9, s63
    v_perm_b32 v92, v14, v10, s62
    v_perm_b32 v93, v14, v10, s63
    v_perm_b32 v94, v15, v11, s62
    v_perm_b32 v95, v15, v11, s63
    v_perm_b32 v96, v20, v16, s62
    v_perm_b32 v97, v20, v16, s63
    v_perm_b32 v98, v21, v17, s62
    v_perm_b32 v99, v21, v17, s63
    v_perm_b32 v100, v22, v18, s62
    v_perm_b32 v101, v22, v18, s63
    v_perm_b32 v102, v23, v19, s62
    v_perm_b32 v103, v23, v19, s63
    v_perm_b32 v104, v28, v24, s62
    v_perm_b32 v105, v28, v24, s63
    v_perm_b32 v106, v29, v25, s62
    v_perm_b32 v107, v29, v25, s63
    v_perm_b32 v108, v30, v26, s62
    v_perm_b32 v109, v30, v26, s63
    v_perm_b32 v110, v31, v27, s62
    v_perm_b32 v111, v31, v27, s63
    v_lshlrev_b32 v136, 3, v0
    ds_bpermute_b32 v148, v137, v32 offset:0
    ds_bpermute_b32 v149, v137, v32 offset:64
    ds_bpermute_b32 v150, v137, v32 offset:128
    s_waitcnt lgkmcnt(0)
    v_dot2_f32_bf16 v140, v88, v148, 0
    v_dot2_f32_bf16 v141, v89, v148, 0
    v_dot2_f32_bf16 v142, v90, v148, 0
    v_dot2_f32_bf16 v143, v91, v148, 0
    v_dot2_f32_bf16 v144, v92, v148, 0
    v_dot2_f32_bf16 v145, v93, v148, 0
    v_dot2_f32_bf16 v146, v94, v148, 0
    v_dot2_f32_bf16 v147, v95, v148, 0
    v_dot2_f32_bf16 v140, v96, v149, v140
    v_dot2_f32_bf16 v141, v97, v149, v141
    v_dot2_f32_bf16 v142, v98, v149, v142
    v_dot2_f32_bf16 v143, v99, v149, v143
    v_dot2_f32_bf16 v144, v100, v149, v144
    v_dot2_f32_bf16 v145, v101, v149, v145
    v_dot2_f32_bf16 v146, v102, v149, v146
    v_dot2_f32_bf16 v147, v103, v149, v147
    v_dot2_f32_bf16 v140, v104, v150, v140
    v_dot2_f32_bf16 v141, v105, v150, v141
    v_dot2_f32_bf16 v142, v106, v150, v142
    v_dot2_f32_bf16 v143, v107, v150, v143
    v_dot2_f32_bf16 v144, v108, v150, v144
    v_dot2_f32_bf16 v145, v109, v150, v145
    v_dot2_f32_bf16 v146, v110, v150, v146
    v_dot2_f32_bf16 v147, v111, v150, v147
    s_nop 2
    v_permlane32_swap_b32 v140, v144
    v_permlane32_swap_b32 v141, v145
    v_permlane32_swap_b32 v142, v146
    v_permlane32_swap_b32 v143, v147
    v_add_f32 v140, v140, v144
    v_add_f32 v141, v141, v145
    v_add_f32 v142, v142, v146
    v_add_f32 v143, v143, v147
    s_nop 0
    v_permlane16_swap_b32 v140, v142
    v_permlane16_swap_b32 v141, v143
    s_nop 0
    v_add_f32 v140, v140, v142
    v_add_f32 v141, v141, v143
    s_nop 0
    s_nop 0
    v_add_f32_dpp v140, v140, v140 row_ror:8 row_mask:0xf bank_mask:0xf
    v_add_f32_dpp v141, v141, v141 row_ror:8 row_mask:0xf bank_mask:0xf
    s_nop 0
    v_add_f32_dpp v140, v140, v140 row_ror:4 row_mask:0xf bank_mask:0xf
    v_add_f32_dpp v141, v141, v141 row_ror:4 row_mask:0xf bank_mask:0xf
    s_nop 0
    ds_write_b64 v139, v[140:141] offset:17408
    ds_bpermute_b32 v148, v137, v33 offset:0
    ds_bpermute_b32 v149, v137, v33 offset:64
    ds_bpermute_b32 v150, v137, v33 offset:128
    s_waitcnt lgkmcnt(0)
    v_dot2_f32_bf16 v140, v88, v148, 0
    v_dot2_f32_bf16 v141, v89, v148, 0
    v_dot2_f32_bf16 v142, v90, v148, 0
    v_dot2_f32_bf16 v143, v91, v148, 0
    v_dot2_f32_bf16 v144, v92, v148, 0
    v_dot2_f32_bf16 v145, v93, v148, 0
    v_dot2_f32_bf16 v146, v94, v148, 0
    v_dot2_f32_bf16 v147, v95, v148, 0
    v_dot2_f32_bf16 v140, v96, v149, v140
    v_dot2_f32_bf16 v141, v97, v149, v141
    v_dot2_f32_bf16 v142, v98, v149, v142
    v_dot2_f32_bf16 v143, v99, v149, v143
    v_dot2_f32_bf16 v144, v100, v149, v144
    v_dot2_f32_bf16 v145, v101, v149, v145
    v_dot2_f32_bf16 v146, v102, v149, v146
    v_dot2_f32_bf16 v147, v103, v149, v147
    v_dot2_f32_bf16 v140, v104, v150, v140
    v_dot2_f32_bf16 v141, v105, v150, v141
    v_dot2_f32_bf16 v142, v106, v150, v142
    v_dot2_f32_bf16 v143, v107, v150, v143
    v_dot2_f32_bf16 v144, v108, v150, v144
    v_dot2_f32_bf16 v145, v109, v150, v145
    v_dot2_f32_bf16 v146, v110, v150, v146
    v_dot2_f32_bf16 v147, v111, v150, v147
    s_nop 2
    v_permlane32_swap_b32 v140, v144
    v_permlane32_swap_b32 v141, v145
    v_permlane32_swap_b32 v142, v146
    v_permlane32_swap_b32 v143, v147
    v_add_f32 v140, v140, v144
    v_add_f32 v141, v141, v145
    v_add_f32 v142, v142, v146
    v_add_f32 v143, v143, v147
    s_nop 0
    v_permlane16_swap_b32 v140, v142
    v_permlane16_swap_b32 v141, v143
    s_nop 0
    v_add_f32 v140, v140, v142
    v_add_f32 v141, v141, v143
    s_nop 0
    s_nop 0
    v_add_f32_dpp v140, v140, v140 row_ror:8 row_mask:0xf bank_mask:0xf
    v_add_f32_dpp v141, v141, v141 row_ror:8 row_mask:0xf bank_mask:0xf
    s_nop 0
    v_add_f32_dpp v140, v140, v140 row_ror:4 row_mask:0xf bank_mask:0xf
    v_add_f32_dpp v141, v141, v141 row_ror:4 row_mask:0xf bank_mask:0xf
    s_nop 0
    ds_write_b64 v139, v[140:141] offset:18432
    s_mov_b64 exec, 1
    ds_add_u32 v2, v3 offset:52
    s_mov_b64 exec, -1

    s_mov_b32 s5, 0
Lspin_112:
    ds_read_b32 v4, v2 offset:44
    s_waitcnt lgkmcnt(0)
    v_readfirstlane_b32 s6, v4
    s_cmp_ge_u32 s6, 1
    s_cbranch_scc1 Lok_113
    s_sleep 1
    s_add_u32 s5, s5, 1
    s_cmp_lt_u32 s5, 1600000
    s_cbranch_scc1 Lspin_112
Lok_113:
    ds_read_b128 v[8:11], v167 offset:0
    ds_read_b128 v[12:15], v167 offset:1280
    ds_read_b128 v[16:19], v167 offset:10240
    ds_read_b128 v[20:23], v167 offset:11520
    ds_read_b128 v[24:27], v167 offset:20480
    ds_read_b128 v[28:31], v167 offset:21760
    ds_read_b128 v[32:35], v167 offset:30720
    ds_read_b128 v[36:39], v167 offset:32000
    s_waitcnt lgkmcnt(0)
    v_perm_b32 v112, v12, v8, s62
    v_perm_b32 v113, v12, v8, s63
    v_perm_b32 v114, v13, v9, s62
    v_perm_b32 v115, v13, v9, s63
    v_perm_b32 v116, v14, v10, s62
    v_perm_b32 v117, v14, v10, s63
    v_perm_b32 v118, v15, v11, s62
    v_perm_b32 v119, v15, v11, s63
    v_perm_b32 v120, v20, v16, s62
    v_perm_b32 v121, v20, v16, s63
    v_perm_b32 v122, v21, v17, s62
    v_perm_b32 v123, v21, v17, s63
    v_perm_b32 v124, v22, v18, s62
    v_perm_b32 v125, v22, v18, s63
    v_perm_b32 v126, v23, v19, s62
    v_perm_b32 v127, v23, v19, s63
    v_perm_b32 v128, v28, v24, s62
    v_perm_b32 v129, v28, v24, s63
    v_perm_b32 v130, v29, v25, s62
    v_perm_b32 v131, v29, v25, s63
    v_perm_b32 v132, v30, v26, s62
    v_perm_b32 v133, v30, v26, s63
    v_perm_b32 v134, v31, v27, s62
    v_perm_b32 v135, v31, v27, s63
    v_perm_b32 v80, v36, v32, s62
    v_perm_b32 v81, v36, v32, s63
    v_perm_b32 v82, v37, v33, s62
    v_perm_b32 v83, v37, v33, s63
    v_perm_b32 v84, v38, v34, s62
    v_perm_b32 v85, v38, v34, s63
    v_perm_b32 v86, v39, v35, s62
    v_perm_b32 v87, v39, v35, s63
    s_mov_b32 s5, 0
Lspin_114:
    ds_read_b32 v4, v2 offset:52
    s_waitcnt lgkmcnt(0)
    v_readfirstlane_b32 s6, v4
    s_cmp_ge_u32 s6, 8
    s_cbranch_scc1 Lok_115
    s_sleep 1
    s_add_u32 s5, s5, 1
    s_cmp_lt_u32 s5, 1600000
    s_cbranch_scc1 Lspin_114
Lok_115:
    ds_read_b64 v[72:73], v165 offset:17408
    ds_read_b64 v[74:75], v165 offset:17440
    ds_read_b64 v[76:77], v165 offset:18432
    ds_read_b64 v[78:79], v165 offset:18464
    s_waitcnt lgkmcnt(0)

    s_nop 0
    v_add_f32_dpp v72, v72, v72 quad_perm:[1,0,3,2] row_mask:0xf bank_mask:0xf
    v_add_f32_dpp v73, v73, v73 quad_perm:[1,0,3,2] row_mask:0xf bank_mask:0xf
    v_add_f32_dpp v74, v74, v74 quad_perm:[1,0,3,2] row_mask:0xf bank_mask:0xf
    v_add_f32_dpp v75, v75, v75 quad_perm:[1,0,3,2] row_mask:0xf bank_mask:0xf
    v_add_f32_dpp v76, v76, v76 quad_perm:[1,0,3,2] row_mask:0xf bank_mask:0xf
    v_add_f32_dpp v77, v77, v77 quad_perm:[1,0,3,2] row_mask:0xf bank_mask:0xf
    v_add_f32_dpp v78, v78, v78 quad_perm:[1,0,3,2] row_mask:0xf bank_mask:0xf
    v_add_f32_dpp v79, v79, v79 quad_perm:[1,0,3,2] row_mask:0xf bank_mask:0xf
    v_add_f32_dpp v72, v72, v72 quad_perm:[2,3,0,1] row_mask:0xf bank_mask:0xf
    v_add_f32_dpp v73, v73, v73 quad_perm:[2,3,0,1] row_mask:0xf bank_mask:0xf
    v_add_f32_dpp v74, v74, v74 quad_perm:[2,3,0,1] row_mask:0xf bank_mask:0xf
    v_add_f32_dpp v75, v75, v75 quad_perm:[2,3,0,1] row_mask:0xf bank_mask:0xf
    v_add_f32_dpp v76, v76, v76 quad_perm:[2,3,0,1] row_mask:0xf bank_mask:0xf
    v_add_f32_dpp v77, v77, v77 quad_perm:[2,3,0,1] row_mask:0xf bank_mask:0xf
    v_add_f32_dpp v78, v78, v78 quad_perm:[2,3,0,1] row_mask:0xf bank_mask:0xf
    v_add_f32_dpp v79, v79, v79 quad_perm:[2,3,0,1] row_mask:0xf bank_mask:0xf
    v_add_f32_dpp v72, v72, v72 row_half_mirror row_mask:0xf bank_mask:0xf
    v_add_f32_dpp v73, v73, v73 row_half_mirror row_mask:0xf bank_mask:0xf
    v_add_f32_dpp v74, v74, v74 row_half_mirror row_mask:0xf bank_mask:0xf
    v_add_f32_dpp v75, v75, v75 row_half_mirror row_mask:0xf bank_mask:0xf
    v_add_f32_dpp v76, v76, v76 row_half_mirror row_mask:0xf bank_mask:0xf
    v_add_f32_dpp v77, v77, v77 row_half_mirror row_mask:0xf bank_mask:0xf
    v_add_f32_dpp v78, v78, v78 row_half_mirror row_mask:0xf bank_mask:0xf
    v_add_f32_dpp v79, v79, v79 row_half_mirror row_mask:0xf bank_mask:0xf
    v_mov_b32 v162, 0x3f80
    v_mov_b32 v163, 0x3f800000
    s_waitcnt vmcnt(0)
    v_and_b32 v157, 0xffff0000, v156
    v_lshlrev_b32 v156, 16, v156

    s_mov_b64 exec, s[28:29]
    s_mov_b32 s5, 0
Lpoll_117:
    s_add_u32 s4, s21, 0
    buffer_load_dwordx2 v[40:41], v136, s[16:19], s4 offen sc1
    s_add_u32 s4, s21, 2560
    buffer_load_dwordx2 v[42:43], v136, s[16:19], s4 offen sc1
    s_add_u32 s4, s21, 5120
    buffer_load_dwordx2 v[44:45], v136, s[16:19], s4 offen sc1
    s_add_u32 s4, s21, 7680
    buffer_load_dwordx2 v[46:47], v136, s[16:19], s4 offen sc1
    s_add_u32 s4, s21, 10240
    buffer_load_dwordx2 v[48:49], v136, s[16:19], s4 offen sc1
    s_add_u32 s4, s21, 12800
    buffer_load_dwordx2 v[50:51], v136, s[16:19], s4 offen sc1
    s_add_u32 s4, s21, 15360
    buffer_load_dwordx2 v[52:53], v136, s[16:19], s4 offen sc1
    s_add_u32 s4, s21, 17920
    buffer_load_dwordx2 v[54:55], v136, s[16:19], s4 offen sc1
    s_add_u32 s4, s21, 20480
    buffer_load_dwordx2 v[56:57], v136, s[16:19], s4 offen sc1
    s_add_u32 s4, s21, 23040
    buffer_load_dwordx2 v[58:59], v136, s[16:19], s4 offen sc1
    s_add_u32 s4, s21, 25600
    buffer_load_dwordx2 v[60:61], v136, s[16:19], s4 offen sc1
    s_add_u32 s4, s21, 28160
    buffer_load_dwordx2 v[62:63], v136, s[16:19], s4 offen sc1
    s_add_u32 s4, s21, 30720
    buffer_load_dwordx2 v[64:65], v136, s[16:19], s4 offen sc1
    s_add_u32 s4, s21, 33280
    buffer_load_dwordx2 v[66:67], v136, s[16:19], s4 offen sc1
    s_add_u32 s4, s21, 35840
    buffer_load_dwordx2 v[68:69], v136, s[16:19], s4 offen sc1
    s_add_u32 s4, s21, 38400
    buffer_load_dwordx2 v[70:71], v136, s[16:19], s4 offen sc1
    s_waitcnt vmcnt(0)
    v_min3_u32 v148, v41, v43, v45
    v_min3_u32 v148, v148, v47, v49
    v_min3_u32 v148, v148, v51, v53
    v_min3_u32 v148, v148, v55, v57
    v_min3_u32 v148, v148, v59, v61
    v_min3_u32 v148, v148, v63, v65
    v_min3_u32 v148, v148, v67, v69
    v_min_u32 v148, v148, v71
    v_max3_u32 v149, v41, v43, v45
    v_max3_u32 v149, v149, v47, v49
    v_max3_u32 v149, v149, v51, v53
    v_max3_u32 v149, v149, v55, v57
    v_max3_u32 v149, v149, v59, v61
    v_max3_u32 v149, v149, v63, v65
    v_max3_u32 v149, v149, v67, v69
    v_max_u32 v149, v149, v71
    v_cmp_ne_u32 s[30:31], s32, v148
    v_cmp_ne_u32 s[6:7], s32, v149
    s_or_b64 s[30:31], s[30:31], s[6:7]
    s_cmp_eq_u64 s[30:31], 0
    s_cbranch_scc1 Lok_118
    s_add_u32 s5, s5, 1
    s_cmp_lt_u32 s5, 400000
    s_cbranch_scc1 Lpoll_117
Lok_118:
Lb_116:
    s_mov_b64 exec, -1
    v_dot2_f32_bf16 v8, v40, v162, 0
    v_dot2_f32_bf16 v10, v40, v163, 0
    v_dot2_f32_bf16 v9, v42, v162, 0
    v_dot2_f32_bf16 v11, v42, v163, 0
    v_dot2_f32_bf16 v8, v44, v162, v8
    v_dot2_f32_bf16 v10, v44, v163, v10
    v_dot2_f32_bf16 v9, v46, v162, v9
    v_dot2_f32_bf16 v11, v46, v163, v11
    v_dot2_f32_bf16 v8, v48, v162, v8
    v_dot2_f32_bf16 v10, v48, v163, v10
    v_dot2_f32_bf16 v9, v50, v162, v9
    v_dot2_f32_bf16 v11, v50, v163, v11
    v_dot2_f32_bf16 v8, v52, v162, v8
    v_dot2_f32_bf16 v10, v52, v163, v10
    v_dot2_f32_bf16 v9, v54, v162, v9
    v_dot2_f32_bf16 v11, v54, v163, v11
    v_dot2_f32_bf16 v8, v56, v162, v8
    v_dot2_f32_bf16 v10, v56, v163, v10
    v_dot2_f32_bf16 v9, v58, v162, v9
    v_dot2_f32_bf16 v11, v58, v163, v11
    v_dot2_f32_bf16 v8, v60, v162, v8
    v_dot2_f32_bf16 v10, v60, v163, v10
    v_dot2_f32_bf16 v9, v62, v162, v9
    v_dot2_f32_bf16 v11, v62, v163, v11
    v_dot2_f32_bf16 v8, v64, v162, v8
    v_dot2_f32_bf16 v10, v64, v163, v10
    v_dot2_f32_bf16 v9, v66, v162, v9
    v_dot2_f32_bf16 v11, v66, v163, v11
    v_dot2_f32_bf16 v8, v68, v162, v8
    v_dot2_f32_bf16 v10, v68, v163, v10
    v_dot2_f32_bf16 v9, v70, v162, v9
    v_dot2_f32_bf16 v11, v70, v163, v11
    s_nop 2
    v_add_f32 v8, v8, v9
    v_add_f32 v10, v10, v11
    v_fma_f32 v8, v8, v158, v156
    v_fma_f32 v9, v10, v159, v157
    v_cvt_pk_bf16_f32 v12, v8, v9
    v_lshlrev_b32 v8, 16, v12
    v_and_b32 v9, 0xffff0000, v12
    v_sub_f32 v12, v8, v151
    v_sub_f32 v13, v9, v151
    v_mul_f32 v12, v12, v160
    v_mul_f32 v13, v13, v161
    v_readfirstlane_b32 s4, v8
    v_cvt_pk_bf16_f32 v12, v12, v13
    v_cndmask_b32 v12, 0, v12, s[28:29]
    s_nop 0

    ds_bpermute_b32 v148, v137, v12 offset:0
    ds_bpermute_b32 v149, v137, v12 offset:64
    ds_bpermute_b32 v150, v137, v12 offset:128
    v_subrev_f32 v16, s4, v8
    v_subrev_f32 v17, s4, v9
    v_cndmask_b32 v16, 0, v16, s[28:29]
    v_cndmask_b32 v17, 0, v17, s[28:29]
    v_mul_f32 v18, v16, v16
    v_add_f32 v16, v16, v17
    v_fmac_f32 v18, v17, v17

    s_nop 0
    s_nop 0
    v_add_f32_dpp v16, v16, v16 row_ror:8 row_mask:0xf bank_mask:0xf
    v_add_f32_dpp v18, v18, v18 row_ror:8 row_mask:0xf bank_mask:0xf
    s_nop 0
    v_add_f32_dpp v16, v16, v16 row_ror:4 row_mask:0xf bank_mask:0xf
    v_add_f32_dpp v18, v18, v18 row_ror:4 row_mask:0xf bank_mask:0xf
    s_nop 0
    v_add_f32_dpp v16, v16, v16 row_ror:2 row_mask:0xf bank_mask:0xf
    v_add_f32_dpp v18, v18, v18 row_ror:2 row_mask:0xf bank_mask:0xf
    s_nop 0
    v_add_f32_dpp v16, v16, v16 row_ror:1 row_mask:0xf bank_mask:0xf
    v_add_f32_dpp v18, v18, v18 row_ror:1 row_mask:0xf bank_mask:0xf
    v_mov_b32 v19, v16
    v_mov_b32 v20, v18
    s_nop 1
    v_permlane16_swap_b32 v16, v19
    v_permlane16_swap_b32 v18, v20
    s_nop 0
    v_add_f32 v16, v16, v19
    v_add_f32 v18, v18, v20
    v_mov_b32 v19, v16
    v_mov_b32 v20, v18
    s_nop 1
    v_permlane32_swap_b32 v16, v19
    v_permlane32_swap_b32 v18, v20
    s_nop 0
    v_add_f32 v16, v16, v19
    v_add_f32 v18, v18, v20
    v_mul_f32 v19, v16, v16
    v_mov_b32 v20, s4
    v_fmac_f32 v18, 0xbc4ccccd, v19
    v_fmac_f32 v16, 0x42a00000, v20
    v_mov_b32 v17, v18
    s_waitcnt lgkmcnt(0)
    ds_write_b64 v138, v[16:17] offset:192

    v_dot2_f32_bf16 v140, v88, v148, 0
    v_dot2_f32_bf16 v141, v89, v148, 0
    v_dot2_f32_bf16 v142, v90, v148, 0
    v_dot2_f32_bf16 v143, v91, v148, 0
    v_dot2_f32_bf16 v144, v92, v148, 0
    v_dot2_f32_bf16 v145, v93, v148, 0
    v_dot2_f32_bf16 v146, v94, v148, 0
    v_dot2_f32_bf16 v147, v95, v148, 0
    v_dot2_f32_bf16 v140, v96, v149, v140
    v_dot2_f32_bf16 v141, v97, v149, v141
    v_dot2_f32_bf16 v142, v98, v149, v142
    v_dot2_f32_bf16 v143, v99, v149, v143
    v_dot2_f32_bf16 v144, v100, v149, v144
    v_dot2_f32_bf16 v145, v101, v149, v145
    v_dot2_f32_bf16 v146, v102, v149, v146
    v_dot2_f32_bf16 v147, v103, v149, v147
    v_dot2_f32_bf16 v140, v104, v150, v140
    v_dot2_f32_bf16 v141, v105, v150, v141
    v_dot2_f32_bf16 v142, v106, v150, v142
    v_dot2_f32_bf16 v143, v107, v150, v143
    v_dot2_f32_bf16 v144, v108, v150, v144
    v_dot2_f32_bf16 v145, v109, v150, v145
    v_dot2_f32_bf16 v146, v110, v150, v146
    v_dot2_f32_bf16 v147, v111, v150, v147
    s_nop 2
    v_permlane32_swap_b32 v140, v144
    v_permlane32_swap_b32 v141, v145
    v_permlane32_swap_b32 v142, v146
    v_permlane32_swap_b32 v143, v147
    v_add_f32 v140, v140, v144
    v_add_f32 v141, v141, v145
    v_add_f32 v142, v142, v146
    v_add_f32 v143, v143, v147
    s_nop 0
    v_permlane16_swap_b32 v140, v142
    v_permlane16_swap_b32 v141, v143
    s_nop 0
    v_add_f32 v140, v140, v142
    v_add_f32 v141, v141, v143
    s_nop 0
    s_nop 0
    v_add_f32_dpp v140, v140, v140 row_ror:8 row_mask:0xf bank_mask:0xf
    v_add_f32_dpp v141, v141, v141 row_ror:8 row_mask:0xf bank_mask:0xf
    s_nop 0
    v_add_f32_dpp v140, v140, v140 row_ror:4 row_mask:0xf bank_mask:0xf
    v_add_f32_dpp v141, v141, v141 row_ror:4 row_mask:0xf bank_mask:0xf
    s_nop 0
    ds_write_b64 v139, v[140:141] offset:16384
    s_mov_b64 exec, 1
    ds_add_u32 v2, v3 offset:36
    s_mov_b64 exec, -1

    s_mov_b32 s5, 0
Lspin_119:
    ds_read_b32 v4, v2 offset:36
    s_waitcnt lgkmcnt(0)
    v_readfirstlane_b32 s6, v4
    s_cmp_ge_u32 s6, 8
    s_cbranch_scc1 Lok_120
    s_add_u32 s5, s5, 1
    s_cmp_lt_u32 s5, 1600000
    s_cbranch_scc1 Lspin_119
Lok_120:
    ds_read_b64 v[12:13], v5 offset:192
    ds_read_b64 v[8:9], v165 offset:16384
    ds_read_b64 v[10:11], v165 offset:16416
    s_waitcnt lgkmcnt(2)
    v_readfirstlane_b32 s4, v12
    v_mov_b32 v14, v13
    s_nop 0
    v_subrev_f32 v12, s4, v12
    v_mul_f32 v13, v12, v12
    s_waitcnt lgkmcnt(0)

    s_nop 0
    v_add_f32_dpp v12, v12, v12 quad_perm:[1,0,3,2] row_mask:0xf bank_mask:0xf
    v_add_f32_dpp v13, v13, v13 quad_perm:[1,0,3,2] row_mask:0xf bank_mask:0xf
    v_add_f32_dpp v14, v14, v14 quad_perm:[1,0,3,2] row_mask:0xf bank_mask:0xf
    v_add_f32_dpp v8, v8, v8 quad_perm:[1,0,3,2] row_mask:0xf bank_mask:0xf
    v_add_f32_dpp v9, v9, v9 quad_perm:[1,0,3,2] row_mask:0xf bank_mask:0xf
    v_add_f32_dpp v10, v10, v10 quad_perm:[1,0,3,2] row_mask:0xf bank_mask:0xf
    v_add_f32_dpp v11, v11, v11 quad_perm:[1,0,3,2] row_mask:0xf bank_mask:0xf
    v_add_f32_dpp v12, v12, v12 quad_perm:[2,3,0,1] row_mask:0xf bank_mask:0xf
    v_add_f32_dpp v13, v13, v13 quad_perm:[2,3,0,1] row_mask:0xf bank_mask:0xf
    v_add_f32_dpp v14, v14, v14 quad_perm:[2,3,0,1] row_mask:0xf bank_mask:0xf
    v_add_f32_dpp v8, v8, v8 quad_perm:[2,3,0,1] row_mask:0xf bank_mask:0xf
    v_add_f32_dpp v9, v9, v9 quad_perm:[2,3,0,1] row_mask:0xf bank_mask:0xf
    v_add_f32_dpp v10, v10, v10 quad_perm:[2,3,0,1] row_mask:0xf bank_mask:0xf
    v_add_f32_dpp v11, v11, v11 quad_perm:[2,3,0,1] row_mask:0xf bank_mask:0xf
    v_add_f32_dpp v12, v12, v12 row_half_mirror row_mask:0xf bank_mask:0xf
    v_add_f32_dpp v13, v13, v13 row_half_mirror row_mask:0xf bank_mask:0xf
    v_add_f32_dpp v14, v14, v14 row_half_mirror row_mask:0xf bank_mask:0xf
    v_add_f32_dpp v8, v8, v8 row_half_mirror row_mask:0xf bank_mask:0xf
    v_add_f32_dpp v9, v9, v9 row_half_mirror row_mask:0xf bank_mask:0xf
    v_add_f32_dpp v10, v10, v10 row_half_mirror row_mask:0xf bank_mask:0xf
    v_add_f32_dpp v11, v11, v11 row_half_mirror row_mask:0xf bank_mask:0xf
    s_nop 0
    v_mul_f32 v15, v12, v12
    v_mov_b32 v16, s4
    v_fmac_f32 v13, 0xbe000000, v15
    v_fmac_f32 v12, 0x41000000, v16
    v_fmac_f32 v14, 0x3c4ccccd, v13
    v_mul_f32 v12, 986500301, v12
    v_sub_f32 v12, v12, v151
    v_mov_b32 v15, 925353388
    v_fmac_f32 v15, 986500301, v14
    v_rsq_f32 v15, v15

    v_fma_f32 v8, -v12, v72, v8
    v_fma_f32 v9, -v12, v73, v9
    v_fma_f32 v10, -v12, v74, v10
    v_fma_f32 v11, -v12, v75, v11
    v_fma_f32 v8, v8, v15, v76
    v_fma_f32 v9, v9, v15, v77
    v_fma_f32 v10, v10, v15, v78
    v_fma_f32 v11, v11, v15, v79
    v_max_f32 v8, 0, v8
    v_max_f32 v9, 0, v9
    v_max_f32 v10, 0, v10
    v_max_f32 v11, 0, v11
    v_cvt_pk_bf16_f32 v8, v8, v9
    v_cvt_pk_bf16_f32 v9, v10, v11
    s_nop 1
    v_mov_b32_dpp v10, v8 row_ror:8 row_mask:0xf bank_mask:0xf
    v_mov_b32_dpp v11, v9 row_ror:8 row_mask:0xf bank_mask:0xf
    s_nop 0
    v_cndmask_b32 v12, v10, v8, s[96:97]
    v_cndmask_b32 v13, v11, v9, s[96:97]
    v_cndmask_b32 v14, v8, v10, s[96:97]
    v_cndmask_b32 v15, v9, v11, s[96:97]

    v_dot2_f32_bf16 v140, v112, v12, 0
    v_dot2_f32_bf16 v141, v113, v12, 0
    v_dot2_f32_bf16 v142, v114, v12, 0
    v_dot2_f32_bf16 v143, v115, v12, 0
    v_dot2_f32_bf16 v144, v116, v12, 0
    v_dot2_f32_bf16 v145, v117, v12, 0
    v_dot2_f32_bf16 v146, v118, v12, 0
    v_dot2_f32_bf16 v147, v119, v12, 0
    v_dot2_f32_bf16 v140, v120, v13, v140
    v_dot2_f32_bf16 v141, v121, v13, v141
    v_dot2_f32_bf16 v142, v122, v13, v142
    v_dot2_f32_bf16 v143, v123, v13, v143
    v_dot2_f32_bf16 v144, v124, v13, v144
    v_dot2_f32_bf16 v145, v125, v13, v145
    v_dot2_f32_bf16 v146, v126, v13, v146
    v_dot2_f32_bf16 v147, v127, v13, v147
    v_dot2_f32_bf16 v140, v128, v14, v140
    v_dot2_f32_bf16 v141, v129, v14, v141
    v_dot2_f32_bf16 v142, v130, v14, v142
    v_dot2_f32_bf16 v143, v131, v14, v143
    v_dot2_f32_bf16 v144, v132, v14, v144
    v_dot2_f32_bf16 v145, v133, v14, v145
    v_dot2_f32_bf16 v146, v134, v14, v146
    v_dot2_f32_bf16 v147, v135, v14, v147
    v_dot2_f32_bf16 v140, v80, v15, v140
    v_dot2_f32_bf16 v141, v81, v15, v141
    v_dot2_f32_bf16 v142, v82, v15, v142
    v_dot2_f32_bf16 v143, v83, v15, v143
    v_dot2_f32_bf16 v144, v84, v15, v144
    v_dot2_f32_bf16 v145, v85, v15, v145
    v_dot2_f32_bf16 v146, v86, v15, v146
    v_dot2_f32_bf16 v147, v87, v15, v147
    s_nop 2
    v_permlane32_swap_b32 v140, v144
    v_permlane32_swap_b32 v141, v145
    v_permlane32_swap_b32 v142, v146
    v_permlane32_swap_b32 v143, v147
    v_add_f32 v140, v140, v144
    v_add_f32 v141, v141, v145
    v_add_f32 v142, v142, v146
    v_add_f32 v143, v143, v147
    s_nop 0
    v_permlane16_swap_b32 v140, v142
    v_permlane16_swap_b32 v141, v143
    s_nop 0
    v_add_f32 v140, v140, v142
    v_add_f32 v141, v141, v143
    v_mov_b32 v152, v140
    v_mov_b32 v154, v141
    buffer_store_dwordx4 v[152:155], v166, s[16:19], s23 offen sc1

    s_cmp_lg_u32 s3, 0
    s_cbranch_scc1 L_sexit
L_sexit:
    s_endpgm
L_comm:
    s_cmp_eq_u32 s3, 9
    s_cbranch_scc1 L_w9
    s_cmp_eq_u32 s3, 10
    s_cbranch_scc1 L_w10

    s_mov_b32 s8, s54
    s_mov_b32 s9, s55
    s_mov_b32 s10, 4915200
    s_mov_b32 s11, 0x00020000

    s_mov_b32 s12, s52
    s_mov_b32 s13, s53
    s_mov_b32 s14, 1280
    s_mov_b32 s15, 0x00020000

    s_mov_b32 s20, s48
    s_mov_b32 s21, s49
    s_mov_b32 s22, 2211840
    s_mov_b32 s23, 0x00020000

    s_sub_u32 s4, s2, 54
    s_sub_u32 s5, s2, 12
    s_cmp_lt_u32 s2, 160
    s_cselect_b32 s100, s2, 999
    s_cmp_ge_u32 s2, 214
    s_cselect_b32 s100, s4, s100
    s_cselect_b32 s4, s5, 999
    s_cmp_eq_u32 s3, 11
    s_cselect_b32 s100, s4, s100
    s_cselect_b32 s29, 7168, 0
    s_and_b32 s24, s100, 3
    s_lshr_b32 s25, s100, 2

    s_cmp_ge_u32 s100, 240
    s_cbranch_scc1 L_w8_nop1a
    s_mul_i32 s4, s24, 320
    v_lshlrev_b32 v3, 1, v0
    buffer_load_ushort v4, v3, s[12:15], s4 offen
    buffer_load_ushort v5, v3, s[12:15], s4 offen offset:128
    buffer_load_ushort v6, v3, s[12:15], s4 offen offset:256
    v_lshrrev_b32 v3, 3, v0
    v_mul_u32_u24 v3, 7680, v3
    v_and_b32 v7, 7, v0
    v_lshl_add_u32 v3, v7, 4, v3
    s_mul_i32 s26, s24, 1228800
    s_lshl_b32 s4, s25, 7
    s_add_u32 s26, s26, s4

    buffer_load_dwordx4 v[8:11], v3, s[8:11], s26 offen nt
    s_add_u32 s26, s26, 61440
    buffer_load_dwordx4 v[12:15], v3, s[8:11], s26 offen nt
    s_add_u32 s26, s26, 61440
    buffer_load_dwordx4 v[16:19], v3, s[8:11], s26 offen nt
    s_add_u32 s26, s26, 61440
    buffer_load_dwordx4 v[20:23], v3, s[8:11], s26 offen nt
    s_add_u32 s26, s26, 61440
    buffer_load_dwordx4 v[24:27], v3, s[8:11], s26 offen nt
    s_add_u32 s26, s26, 61440
    buffer_load_dwordx4 v[28:31], v3, s[8:11], s26 offen nt
    s_add_u32 s26, s26, 61440
    buffer_load_dwordx4 v[32:35], v3, s[8:11], s26 offen nt
    s_add_u32 s26, s26, 61440
    buffer_load_dwordx4 v[36:39], v3, s[8:11], s26 offen nt
    s_add_u32 s26, s26, 61440
    buffer_load_dwordx4 v[40:43], v3, s[8:11], s26 offen nt
    s_add_u32 s26, s26, 61440
    buffer_load_dwordx4 v[44:47], v3, s[8:11], s26 offen nt
    s_add_u32 s26, s26, 61440
    buffer_load_dwordx4 v[48:51], v3, s[8:11], s26 offen nt
    s_add_u32 s26, s26, 61440
    buffer_load_dwordx4 v[52:55], v3, s[8:11], s26 offen nt
    s_add_u32 s26, s26, 61440
    buffer_load_dwordx4 v[56:59], v3, s[8:11], s26 offen nt
    s_add_u32 s26, s26, 61440
    buffer_load_dwordx4 v[60:63], v3, s[8:11], s26 offen nt
    s_add_u32 s26, s26, 61440
    buffer_load_dwordx4 v[64:67], v3, s[8:11], s26 offen nt
    s_add_u32 s26, s26, 61440
    buffer_load_dwordx4 v[68:71], v3, s[8:11], s26 offen nt
    s_add_u32 s26, s26, 61440
    buffer_load_dwordx4 v[72:75], v3, s[8:11], s26 offen nt
    s_add_u32 s26, s26, 61440
    buffer_load_dwordx4 v[76:79], v3, s[8:11], s26 offen nt
    s_add_u32 s26, s26, 61440
    buffer_load_dwordx4 v[80:83], v3, s[8:11], s26 offen nt
    s_add_u32 s26, s26, 61440
    buffer_load_dwordx4 v[84:87], v3, s[8:11], s26 offen nt
    s_add_u32 s26, s26, 61440
    s_waitcnt vmcnt(23)
L_w8_nop1a:
    s_barrier
    s_waitcnt lgkmcnt(0)
    s_mul_i32 s32, s32, 0x9e3779b1
    s_add_u32 s32, s32, 0x7f4a7c15
    s_cmp_ge_u32 s100, 240
    s_cbranch_scc1 Lnop1_121
    s_waitcnt vmcnt(20)

    v_lshlrev_b32 v4, 16, v4
    v_mul_f32 v98, 0xbfb8aa3b, v4
    v_exp_f32 v98, v98
    s_nop 0
    v_add_f32 v98, 1.0, v98
    v_rcp_f32 v99, v98
    s_nop 0
    v_mul_f32 v4, v4, v99
    v_cvt_pk_bf16_f32 v4, v4, v4

    v_lshlrev_b32 v5, 16, v5
    v_mul_f32 v98, 0xbfb8aa3b, v5
    v_exp_f32 v98, v98
    s_nop 0
    v_add_f32 v98, 1.0, v98
    v_rcp_f32 v99, v98
    s_nop 0
    v_mul_f32 v5, v5, v99
    v_cvt_pk_bf16_f32 v5, v5, v5

    v_lshlrev_b32 v6, 16, v6
    v_mul_f32 v98, 0xbfb8aa3b, v6
    v_exp_f32 v98, v98
    s_nop 0
    v_add_f32 v98, 1.0, v98
    v_rcp_f32 v99, v98
    s_nop 0
    v_mul_f32 v6, v6, v99
    v_cvt_pk_bf16_f32 v6, v6, v6

    v_and_b32 v7, 7, v0
    v_mul_u32_u24 v7, 20, v7
    v_lshrrev_b32 v98, 3, v0
    v_add_u32 v7, v7, v98
    v_lshl_add_u32 v7, v7, 1, s29
    ds_write_b16 v7, v4 offset:512
    ds_write_b16 v7, v5 offset:528
    s_mov_b32 exec_lo, -1
    s_mov_b32 exec_hi, 0
    ds_write_b16 v7, v6 offset:544
    s_mov_b64 exec, -1
    v_lshrrev_b32 v7, 3, v0
    v_mul_u32_u24 v7, 40, v7
    v_add_u32 v7, s29, v7
    s_waitcnt lgkmcnt(0)

    ds_read_b64 v[88:89], v7 offset:512
    ds_read_b64 v[90:91], v7 offset:520
    ds_read_b64 v[92:93], v7 offset:528
    ds_read_b64 v[94:95], v7 offset:536
    ds_read_b64 v[96:97], v7 offset:544
    v_and_b32 v3, 7, v0
    v_lshlrev_b32 v3, 3, v3
    v_lshrrev_b32 v4, 5, v0
    v_lshl_add_u32 v3, v4, 2, v3
    v_bfe_u32 v4, v0, 4, 1
    v_lshl_add_u32 v3, v4, 1, v3

    v_lshlrev_b32 v3, 3, v3
    s_mul_i32 s27, s24, 30720
    s_lshl_b32 s6, s25, 9
    s_add_u32 s27, s27, s6
    s_add_u32 s27, s27, 4096
    s_waitcnt lgkmcnt(0)
    v_mov_b32 v5, s32
    v_mov_b32 v7, s32

    s_waitcnt vmcnt(18)
    v_perm_b32 v108, v12, v8, s62
    v_perm_b32 v110, v12, v8, s63
    v_dot2_f32_bf16 v100, v108, v88, 0
    v_dot2_f32_bf16 v101, v110, v88, 0
    v_perm_b32 v109, v13, v9, s62
    v_perm_b32 v111, v13, v9, s63
    v_dot2_f32_bf16 v102, v109, v88, 0
    v_dot2_f32_bf16 v103, v111, v88, 0
    v_perm_b32 v108, v14, v10, s62
    v_perm_b32 v110, v14, v10, s63
    v_dot2_f32_bf16 v104, v108, v88, 0
    v_dot2_f32_bf16 v105, v110, v88, 0
    v_perm_b32 v109, v15, v11, s62
    v_perm_b32 v111, v15, v11, s63
    v_dot2_f32_bf16 v106, v109, v88, 0
    v_dot2_f32_bf16 v107, v111, v88, 0
    s_waitcnt vmcnt(16)
    v_perm_b32 v108, v20, v16, s62
    v_perm_b32 v110, v20, v16, s63
    v_dot2_f32_bf16 v100, v108, v89, v100
    v_dot2_f32_bf16 v101, v110, v89, v101
    v_perm_b32 v109, v21, v17, s62
    v_perm_b32 v111, v21, v17, s63
    v_dot2_f32_bf16 v102, v109, v89, v102
    v_dot2_f32_bf16 v103, v111, v89, v103
    v_perm_b32 v108, v22, v18, s62
    v_perm_b32 v110, v22, v18, s63
    v_dot2_f32_bf16 v104, v108, v89, v104
    v_dot2_f32_bf16 v105, v110, v89, v105
    v_perm_b32 v109, v23, v19, s62
    v_perm_b32 v111, v23, v19, s63
    v_dot2_f32_bf16 v106, v109, v89, v106
    v_dot2_f32_bf16 v107, v111, v89, v107
    s_waitcnt vmcnt(14)
    v_perm_b32 v108, v28, v24, s62
    v_perm_b32 v110, v28, v24, s63
    v_dot2_f32_bf16 v100, v108, v90, v100
    v_dot2_f32_bf16 v101, v110, v90, v101
    v_perm_b32 v109, v29, v25, s62
    v_perm_b32 v111, v29, v25, s63
    v_dot2_f32_bf16 v102, v109, v90, v102
    v_dot2_f32_bf16 v103, v111, v90, v103
    v_perm_b32 v108, v30, v26, s62
    v_perm_b32 v110, v30, v26, s63
    v_dot2_f32_bf16 v104, v108, v90, v104
    v_dot2_f32_bf16 v105, v110, v90, v105
    v_perm_b32 v109, v31, v27, s62
    v_perm_b32 v111, v31, v27, s63
    v_dot2_f32_bf16 v106, v109, v90, v106
    v_dot2_f32_bf16 v107, v111, v90, v107
    s_waitcnt vmcnt(12)
    v_perm_b32 v108, v36, v32, s62
    v_perm_b32 v110, v36, v32, s63
    v_dot2_f32_bf16 v100, v108, v91, v100
    v_dot2_f32_bf16 v101, v110, v91, v101
    v_perm_b32 v109, v37, v33, s62
    v_perm_b32 v111, v37, v33, s63
    v_dot2_f32_bf16 v102, v109, v91, v102
    v_dot2_f32_bf16 v103, v111, v91, v103
    v_perm_b32 v108, v38, v34, s62
    v_perm_b32 v110, v38, v34, s63
    v_dot2_f32_bf16 v104, v108, v91, v104
    v_dot2_f32_bf16 v105, v110, v91, v105
    v_perm_b32 v109, v39, v35, s62
    v_perm_b32 v111, v39, v35, s63
    v_dot2_f32_bf16 v106, v109, v91, v106
    v_dot2_f32_bf16 v107, v111, v91, v107
    s_waitcnt vmcnt(10)
    v_perm_b32 v108, v44, v40, s62
    v_perm_b32 v110, v44, v40, s63
    v_dot2_f32_bf16 v100, v108, v92, v100
    v_dot2_f32_bf16 v101, v110, v92, v101
    v_perm_b32 v109, v45, v41, s62
    v_perm_b32 v111, v45, v41, s63
    v_dot2_f32_bf16 v102, v109, v92, v102
    v_dot2_f32_bf16 v103, v111, v92, v103
    v_perm_b32 v108, v46, v42, s62
    v_perm_b32 v110, v46, v42, s63
    v_dot2_f32_bf16 v104, v108, v92, v104
    v_dot2_f32_bf16 v105, v110, v92, v105
    v_perm_b32 v109, v47, v43, s62
    v_perm_b32 v111, v47, v43, s63
    v_dot2_f32_bf16 v106, v109, v92, v106
    v_dot2_f32_bf16 v107, v111, v92, v107
    s_waitcnt vmcnt(8)
    v_perm_b32 v108, v52, v48, s62
    v_perm_b32 v110, v52, v48, s63
    v_dot2_f32_bf16 v100, v108, v93, v100
    v_dot2_f32_bf16 v101, v110, v93, v101
    v_perm_b32 v109, v53, v49, s62
    v_perm_b32 v111, v53, v49, s63
    v_dot2_f32_bf16 v102, v109, v93, v102
    v_dot2_f32_bf16 v103, v111, v93, v103
    v_perm_b32 v108, v54, v50, s62
    v_perm_b32 v110, v54, v50, s63
    v_dot2_f32_bf16 v104, v108, v93, v104
    v_dot2_f32_bf16 v105, v110, v93, v105
    v_perm_b32 v109, v55, v51, s62
    v_perm_b32 v111, v55, v51, s63
    v_dot2_f32_bf16 v106, v109, v93, v106
    v_dot2_f32_bf16 v107, v111, v93, v107
    s_waitcnt vmcnt(6)
    v_perm_b32 v108, v60, v56, s62
    v_perm_b32 v110, v60, v56, s63
    v_dot2_f32_bf16 v100, v108, v94, v100
    v_dot2_f32_bf16 v101, v110, v94, v101
    v_perm_b32 v109, v61, v57, s62
    v_perm_b32 v111, v61, v57, s63
    v_dot2_f32_bf16 v102, v109, v94, v102
    v_dot2_f32_bf16 v103, v111, v94, v103
    v_perm_b32 v108, v62, v58, s62
    v_perm_b32 v110, v62, v58, s63
    v_dot2_f32_bf16 v104, v108, v94, v104
    v_dot2_f32_bf16 v105, v110, v94, v105
    v_perm_b32 v109, v63, v59, s62
    v_perm_b32 v111, v63, v59, s63
    v_dot2_f32_bf16 v106, v109, v94, v106
    v_dot2_f32_bf16 v107, v111, v94, v107
    s_waitcnt vmcnt(4)
    v_perm_b32 v108, v68, v64, s62
    v_perm_b32 v110, v68, v64, s63
    v_dot2_f32_bf16 v100, v108, v95, v100
    v_dot2_f32_bf16 v101, v110, v95, v101
    v_perm_b32 v109, v69, v65, s62
    v_perm_b32 v111, v69, v65, s63
    v_dot2_f32_bf16 v102, v109, v95, v102
    v_dot2_f32_bf16 v103, v111, v95, v103
    v_perm_b32 v108, v70, v66, s62
    v_perm_b32 v110, v70, v66, s63
    v_dot2_f32_bf16 v104, v108, v95, v104
    v_dot2_f32_bf16 v105, v110, v95, v105
    v_perm_b32 v109, v71, v67, s62
    v_perm_b32 v111, v71, v67, s63
    v_dot2_f32_bf16 v106, v109, v95, v106
    v_dot2_f32_bf16 v107, v111, v95, v107
    s_waitcnt vmcnt(2)
    v_perm_b32 v108, v76, v72, s62
    v_perm_b32 v110, v76, v72, s63
    v_dot2_f32_bf16 v100, v108, v96, v100
    v_dot2_f32_bf16 v101, v110, v96, v101
    v_perm_b32 v109, v77, v73, s62
    v_perm_b32 v111, v77, v73, s63
    v_dot2_f32_bf16 v102, v109, v96, v102
    v_dot2_f32_bf16 v103, v111, v96, v103
    v_perm_b32 v108, v78, v74, s62
    v_perm_b32 v110, v78, v74, s63
    v_dot2_f32_bf16 v104, v108, v96, v104
    v_dot2_f32_bf16 v105, v110, v96, v105
    v_perm_b32 v109, v79, v75, s62
    v_perm_b32 v111, v79, v75, s63
    v_dot2_f32_bf16 v106, v109, v96, v106
    v_dot2_f32_bf16 v107, v111, v96, v107
    s_waitcnt vmcnt(0)
    v_perm_b32 v108, v84, v80, s62
    v_perm_b32 v110, v84, v80, s63
    v_dot2_f32_bf16 v100, v108, v97, v100
    v_dot2_f32_bf16 v101, v110, v97, v101
    v_perm_b32 v109, v85, v81, s62
    v_perm_b32 v111, v85, v81, s63
    v_dot2_f32_bf16 v102, v109, v97, v102
    v_dot2_f32_bf16 v103, v111, v97, v103
    v_perm_b32 v108, v86, v82, s62
    v_perm_b32 v110, v86, v82, s63
    v_dot2_f32_bf16 v104, v108, v97, v104
    v_dot2_f32_bf16 v105, v110, v97, v105
    v_perm_b32 v109, v87, v83, s62
    v_perm_b32 v111, v87, v83, s63
    v_dot2_f32_bf16 v106, v109, v97, v106
    v_dot2_f32_bf16 v107, v111, v97, v107
    s_nop 2
    v_permlane32_swap_b32 v100, v104
    v_permlane32_swap_b32 v101, v105
    v_permlane32_swap_b32 v102, v106
    v_permlane32_swap_b32 v103, v107
    v_add_f32 v100, v100, v104
    v_add_f32 v101, v101, v105
    v_add_f32 v102, v102, v106
    v_add_f32 v103, v103, v107
    s_nop 0
    v_permlane16_swap_b32 v100, v102
    v_permlane16_swap_b32 v101, v103
    s_nop 0
    v_add_f32 v100, v100, v102
    v_add_f32 v101, v101, v103
    s_nop 0
    s_nop 0
    v_add_f32_dpp v100, v100, v100 row_ror:8 row_mask:0xf bank_mask:0xf
    v_add_f32_dpp v101, v101, v101 row_ror:8 row_mask:0xf bank_mask:0xf
    s_nop 0
    v_mov_b32 v4, v100
    v_mov_b32 v6, v101
    s_mov_b32 s6, 0x00ff00ff
    s_mov_b32 s7, 0x00ff00ff
    s_mov_b64 exec, s[6:7]
    buffer_store_dwordx4 v[4:7], v3, s[16:19], s27 offen sc1
    s_mov_b64 exec, -1

Lnop1_121:
    s_cmp_eq_u32 s3, 11
    s_cbranch_scc1 L_w11
    v_mov_b32 v8, 1
    ds_write_b32 v2, v8 offset:16
    s_cmp_ge_u32 s35, 54
    s_cbranch_scc1 Lnomlp_122
    v_lshrrev_b32 v3, 2, v0
    v_mul_u32_u24 v3, 6912, v3
    v_and_b32 v4, 3, v0
    v_lshl_add_u32 v3, v4, 4, v3
    v_cmp_gt_u32 vcc, 32, v0
    v_mov_b32 v5, 2147483392
    s_lshl_b32 s28, s35, 6
    v_cndmask_b32 v5, v5, v3, vcc
    s_mov_b32 s29, 20480

    s_mov_b32 s5, 0
Lspin_123:
    ds_read_b32 v8, v2 offset:40
    s_waitcnt lgkmcnt(0)
    v_readfirstlane_b32 s6, v8
    s_cmp_ge_u32 s6, 4
    s_cbranch_scc1 Lok_124
    s_sleep 4
    s_add_u32 s5, s5, 1
    s_cmp_lt_u32 s5, 1600000
    s_cbranch_scc1 Lspin_123
Lok_124:
Lw1_125:
    s_mov_b32 m0, s29
    s_add_u32 s4, s28, 0
    buffer_load_dwordx4 v3, s[20:23], s4 offen  lds
    s_add_u32 s29, s29, 1024
    s_waitcnt vmcnt(60)
    s_mov_b32 m0, s29
    s_add_u32 s4, s28, 3456
    buffer_load_dwordx4 v3, s[20:23], s4 offen  lds
    s_add_u32 s29, s29, 1024
    s_waitcnt vmcnt(60)
    s_mov_b32 m0, s29
    s_add_u32 s4, s28, 110592
    buffer_load_dwordx4 v3, s[20:23], s4 offen  lds
    s_add_u32 s29, s29, 1024
    s_waitcnt vmcnt(60)
    s_mov_b32 m0, s29
    s_add_u32 s4, s28, 114048
    buffer_load_dwordx4 v3, s[20:23], s4 offen  lds
    s_add_u32 s29, s29, 1024
    s_waitcnt vmcnt(60)
    s_mov_b32 m0, s29
    s_add_u32 s4, s28, 221184
    buffer_load_dwordx4 v5, s[20:23], s4 offen  lds
    s_add_u32 s29, s29, 1024
    s_waitcnt vmcnt(60)
    s_mov_b32 m0, s29
    s_add_u32 s4, s28, 224640
    buffer_load_dwordx4 v5, s[20:23], s4 offen  lds
    s_add_u32 s29, s29, 1024
    s_waitcnt vmcnt(60)
    s_add_u32 s28, s28, 276480
    s_cmp_lt_u32 s29, 69632
    s_cbranch_scc1 Lw1_125

    v_mov_b32 v4, 1
    ds_write_b32 v2, v4 offset:56
    s_waitcnt vmcnt(0)
    v_mov_b32 v4, 1
    s_mov_b64 exec, 1
    ds_add_u32 v2, v4 offset:20
    s_mov_b64 exec, -1
    s_waitcnt lgkmcnt(0)
Lnomlp_122:
    s_branch L_end
L_w9:
    s_mov_b32 s8, s42
    s_mov_b32 s9, s43
    s_mov_b32 s10, 5242880
    s_mov_b32 s11, 0x00020000

    s_mov_b32 s12, s36
    s_mov_b32 s13, s37
    s_mov_b32 s14, 1280
    s_mov_b32 s15, 0x00020000

    v_mul_u32_u24 v3, 20, v0
    buffer_load_dwordx4 v[112:115], v3, s[12:15], 0 offen
    buffer_load_dword v116, v3, s[12:15], 0 offen offset:16
    v_lshlrev_b32 v3, 2, v0
    s_mul_i32 s4, s34, 160
    buffer_load_dword v117, v3, s[12:15], s4 offen
    v_lshrrev_b32 v3, 4, v0
    v_lshlrev_b32 v3, 13, v3
    v_and_b32 v4, 15, v0
    v_lshl_add_u32 v3, v4, 4, v3
    s_mul_i32 s28, s34, 655360
    s_lshl_b32 s4, s33, 8
    s_add_u32 s28, s28, s4
    s_barrier

    buffer_load_dwordx4 v[8:11], v3, s[8:11], s28 offen nt
    s_add_u32 s28, s28, 32768
    buffer_load_dwordx4 v[12:15], v3, s[8:11], s28 offen nt
    s_add_u32 s28, s28, 32768
    buffer_load_dwordx4 v[16:19], v3, s[8:11], s28 offen nt
    s_add_u32 s28, s28, 32768
    buffer_load_dwordx4 v[20:23], v3, s[8:11], s28 offen nt
    s_add_u32 s28, s28, 32768
    buffer_load_dwordx4 v[24:27], v3, s[8:11], s28 offen nt
    s_add_u32 s28, s28, 32768
    buffer_load_dwordx4 v[28:31], v3, s[8:11], s28 offen nt
    s_add_u32 s28, s28, 32768
    buffer_load_dwordx4 v[32:35], v3, s[8:11], s28 offen nt
    s_add_u32 s28, s28, 32768
    buffer_load_dwordx4 v[36:39], v3, s[8:11], s28 offen nt
    s_add_u32 s28, s28, 32768
    buffer_load_dwordx4 v[40:43], v3, s[8:11], s28 offen nt
    s_add_u32 s28, s28, 32768
    buffer_load_dwordx4 v[44:47], v3, s[8:11], s28 offen nt
    s_add_u32 s28, s28, 32768
    buffer_load_dwordx4 v[48:51], v3, s[8:11], s28 offen nt
    s_add_u32 s28, s28, 32768
    buffer_load_dwordx4 v[52:55], v3, s[8:11], s28 offen nt
    s_add_u32 s28, s28, 32768
    buffer_load_dwordx4 v[56:59], v3, s[8:11], s28 offen nt
    s_add_u32 s28, s28, 32768
    buffer_load_dwordx4 v[60:63], v3, s[8:11], s28 offen nt
    s_add_u32 s28, s28, 32768
    buffer_load_dwordx4 v[64:67], v3, s[8:11], s28 offen nt
    s_add_u32 s28, s28, 32768
    buffer_load_dwordx4 v[68:71], v3, s[8:11], s28 offen nt
    s_add_u32 s28, s28, 32768
    buffer_load_dwordx4 v[72:75], v3, s[8:11], s28 offen nt
    s_add_u32 s28, s28, 32768
    buffer_load_dwordx4 v[76:79], v3, s[8:11], s28 offen nt
    s_add_u32 s28, s28, 32768
    buffer_load_dwordx4 v[80:83], v3, s[8:11], s28 offen nt
    s_add_u32 s28, s28, 32768
    buffer_load_dwordx4 v[84:87], v3, s[8:11], s28 offen nt
    s_add_u32 s28, s28, 32768
    s_waitcnt vmcnt(20)
    v_lshlrev_b32 v120, 16, v112
    v_and_b32 v121, 0xffff0000, v112
    v_lshlrev_b32 v122, 16, v113
    v_and_b32 v123, 0xffff0000, v113
    v_lshlrev_b32 v124, 16, v114
    v_and_b32 v125, 0xffff0000, v114
    v_lshlrev_b32 v126, 16, v115
    v_and_b32 v127, 0xffff0000, v115
    v_lshlrev_b32 v128, 16, v116
    v_and_b32 v129, 0xffff0000, v116
    v_add_f32 v130, v120, v121
    v_add_f32 v130, v130, v122
    v_add_f32 v130, v130, v123
    v_add_f32 v130, v130, v124
    v_add_f32 v130, v130, v125
    v_add_f32 v130, v130, v126
    v_add_f32 v130, v130, v127
    v_add_f32 v130, v130, v128
    v_add_f32 v130, v130, v129
    s_nop 0
    s_nop 1
    v_add_f32_dpp v130, v130, v130 row_ror:8 row_mask:0xf bank_mask:0xf
    s_nop 1
    v_add_f32_dpp v130, v130, v130 row_ror:4 row_mask:0xf bank_mask:0xf
    s_nop 1
    v_add_f32_dpp v130, v130, v130 row_ror:2 row_mask:0xf bank_mask:0xf
    s_nop 1
    v_add_f32_dpp v130, v130, v130 row_ror:1 row_mask:0xf bank_mask:0xf
    v_mov_b32 v131, v130
    s_nop 1
    v_permlane16_swap_b32 v130, v131
    s_nop 0
    v_add_f32 v130, v130, v131
    v_mov_b32 v131, v130
    s_nop 1
    v_permlane32_swap_b32 v130, v131
    s_nop 0
    v_add_f32 v130, v130, v131
    v_mul_f32 v130, 986500301, v130
    v_sub_f32 v132, v120, v130
    v_mul_f32 v131, v132, v132
    v_sub_f32 v132, v121, v130
    v_fmac_f32 v131, v132, v132
    v_sub_f32 v132, v122, v130
    v_fmac_f32 v131, v132, v132
    v_sub_f32 v132, v123, v130
    v_fmac_f32 v131, v132, v132
    v_sub_f32 v132, v124, v130
    v_fmac_f32 v131, v132, v132
    v_sub_f32 v132, v125, v130
    v_fmac_f32 v131, v132, v132
    v_sub_f32 v132, v126, v130
    v_fmac_f32 v131, v132, v132
    v_sub_f32 v132, v127, v130
    v_fmac_f32 v131, v132, v132
    v_sub_f32 v132, v128, v130
    v_fmac_f32 v131, v132, v132
    v_sub_f32 v132, v129, v130
    v_fmac_f32 v131, v132, v132
    s_nop 0
    s_nop 1
    v_add_f32_dpp v131, v131, v131 row_ror:8 row_mask:0xf bank_mask:0xf
    s_nop 1
    v_add_f32_dpp v131, v131, v131 row_ror:4 row_mask:0xf bank_mask:0xf
    s_nop 1
    v_add_f32_dpp v131, v131, v131 row_ror:2 row_mask:0xf bank_mask:0xf
    s_nop 1
    v_add_f32_dpp v131, v131, v131 row_ror:1 row_mask:0xf bank_mask:0xf
    v_mov_b32 v132, v131
    s_nop 1
    v_permlane16_swap_b32 v131, v132
    s_nop 0
    v_add_f32 v131, v131, v132
    v_mov_b32 v132, v131
    s_nop 1
    v_permlane32_swap_b32 v131, v132
    s_nop 0
    v_add_f32 v131, v131, v132
    v_mul_f32 v131, 986500301, v131
    v_cvt_pk_bf16_f32 v132, v130, v131
    v_lshlrev_b32 v130, 16, v132
    v_and_b32 v131, 0xffff0000, v132
    ds_write_b32 v2, v130 offset:136
    v_add_f32 v131, 925353388, v131
    v_cvt_pk_bf16_f32 v131, v131, v131
    v_and_b32 v131, 0xffff0000, v131
    v_sqrt_f32 v131, v131
    s_nop 0
    v_cvt_pk_bf16_f32 v131, v131, v131
    v_and_b32 v131, 0xffff0000, v131
    v_rcp_f32 v132, v131
    v_lshlrev_b32 v118, 16, v117
    v_and_b32 v119, 0xffff0000, v117
    v_sub_f32 v118, v118, v130
    v_cvt_pk_bf16_f32 v118, v118, v118
    v_and_b32 v118, 0xffff0000, v118
    v_mul_f32 v133, v118, v132
    v_fma_f32 v134, -v133, v131, v118
    v_fma_f32 v118, v134, v132, v133
    v_cvt_pk_bf16_f32 v118, v118, v118
    v_and_b32 v118, 0xffff0000, v118
    v_sub_f32 v119, v119, v130
    v_cvt_pk_bf16_f32 v119, v119, v119
    v_and_b32 v119, 0xffff0000, v119
    v_mul_f32 v133, v119, v132
    v_fma_f32 v134, -v133, v131, v119
    v_fma_f32 v119, v134, v132, v133
    v_cvt_pk_bf16_f32 v119, v119, v119
    v_and_b32 v119, 0xffff0000, v119
    v_cmp_gt_u32 s[96:97], 40, v0
    v_mov_b32 v4, 2147483392
    s_waitcnt vmcnt(0) lgkmcnt(0)
    v_cndmask_b32 v4, v4, v1, s[96:97]
    s_mul_i32 s32, s32, 0x9e3779b1
    s_add_u32 s32, s32, 0x7f4a7c15
    s_mul_i32 s28, s34, 640
    s_add_u32 s28, s28, 4096

    s_mov_b32 s5, 0
Lspin_126:
    ds_read_b32 v6, v2 offset:16
    s_waitcnt lgkmcnt(0)
    v_readfirstlane_b32 s6, v6
    s_cmp_ge_u32 s6, 1
    s_cbranch_scc1 Lok_127
    s_sleep 4
    s_add_u32 s5, s5, 1
    s_cmp_lt_u32 s5, 1600000
    s_cbranch_scc1 Lspin_126
Lok_127:
    s_mov_b32 s5, 0
Lpoll_128:
    s_add_u32 s4, s28, 0
    buffer_load_dwordx4 v[136:139], v4, s[16:19], s4 offen sc1
    s_add_u32 s4, s28, 5120
    buffer_load_dwordx4 v[140:143], v4, s[16:19], s4 offen sc1
    s_add_u32 s4, s28, 30720
    buffer_load_dwordx4 v[144:147], v4, s[16:19], s4 offen sc1
    s_add_u32 s4, s28, 35840
    buffer_load_dwordx4 v[148:151], v4, s[16:19], s4 offen sc1
    s_add_u32 s4, s28, 61440
    buffer_load_dwordx4 v[152:155], v4, s[16:19], s4 offen sc1
    s_add_u32 s4, s28, 66560
    buffer_load_dwordx4 v[156:159], v4, s[16:19], s4 offen sc1
    s_add_u32 s4, s28, 92160
    buffer_load_dwordx4 v[160:163], v4, s[16:19], s4 offen sc1
    s_add_u32 s4, s28, 97280
    buffer_load_dwordx4 v[164:167], v4, s[16:19], s4 offen sc1
    s_waitcnt vmcnt(0)
    v_cmp_ne_u32 s[30:31], s32, v137
    s_and_b64 s[30:31], s[30:31], s[96:97]
    v_cmp_ne_u32 s[6:7], s32, v139
    s_and_b64 s[6:7], s[6:7], s[96:97]
    s_or_b64 s[30:31], s[30:31], s[6:7]
    v_cmp_ne_u32 s[6:7], s32, v141
    s_and_b64 s[6:7], s[6:7], s[96:97]
    s_or_b64 s[30:31], s[30:31], s[6:7]
    v_cmp_ne_u32 s[6:7], s32, v143
    s_and_b64 s[6:7], s[6:7], s[96:97]
    s_or_b64 s[30:31], s[30:31], s[6:7]
    v_cmp_ne_u32 s[6:7], s32, v145
    s_and_b64 s[6:7], s[6:7], s[96:97]
    s_or_b64 s[30:31], s[30:31], s[6:7]
    v_cmp_ne_u32 s[6:7], s32, v147
    s_and_b64 s[6:7], s[6:7], s[96:97]
    s_or_b64 s[30:31], s[30:31], s[6:7]
    v_cmp_ne_u32 s[6:7], s32, v149
    s_and_b64 s[6:7], s[6:7], s[96:97]
    s_or_b64 s[30:31], s[30:31], s[6:7]
    v_cmp_ne_u32 s[6:7], s32, v151
    s_and_b64 s[6:7], s[6:7], s[96:97]
    s_or_b64 s[30:31], s[30:31], s[6:7]
    v_cmp_ne_u32 s[6:7], s32, v153
    s_and_b64 s[6:7], s[6:7], s[96:97]
    s_or_b64 s[30:31], s[30:31], s[6:7]
    v_cmp_ne_u32 s[6:7], s32, v155
    s_and_b64 s[6:7], s[6:7], s[96:97]
    s_or_b64 s[30:31], s[30:31], s[6:7]
    v_cmp_ne_u32 s[6:7], s32, v157
    s_and_b64 s[6:7], s[6:7], s[96:97]
    s_or_b64 s[30:31], s[30:31], s[6:7]
    v_cmp_ne_u32 s[6:7], s32, v159
    s_and_b64 s[6:7], s[6:7], s[96:97]
    s_or_b64 s[30:31], s[30:31], s[6:7]
    v_cmp_ne_u32 s[6:7], s32, v161
    s_and_b64 s[6:7], s[6:7], s[96:97]
    s_or_b64 s[30:31], s[30:31], s[6:7]
    v_cmp_ne_u32 s[6:7], s32, v163
    s_and_b64 s[6:7], s[6:7], s[96:97]
    s_or_b64 s[30:31], s[30:31], s[6:7]
    v_cmp_ne_u32 s[6:7], s32, v165
    s_and_b64 s[6:7], s[6:7], s[96:97]
    s_or_b64 s[30:31], s[30:31], s[6:7]
    v_cmp_ne_u32 s[6:7], s32, v167
    s_and_b64 s[6:7], s[6:7], s[96:97]
    s_or_b64 s[30:31], s[30:31], s[6:7]
    s_cmp_eq_u64 s[30:31], 0
    s_cbranch_scc1 Lok_129
    s_sleep 2
    s_add_u32 s5, s5, 1
    s_cmp_lt_u32 s5, 400000
    s_cbranch_scc1 Lpoll_128
Lok_129:
    v_add_f32 v136, v136, v144
    v_add_f32 v138, v138, v146
    v_add_f32 v140, v140, v148
    v_add_f32 v142, v142, v150
    v_add_f32 v136, v136, v152
    v_add_f32 v138, v138, v154
    v_add_f32 v140, v140, v156
    v_add_f32 v142, v142, v158
    v_add_f32 v136, v136, v160
    v_add_f32 v138, v138, v162
    v_add_f32 v140, v140, v164
    v_add_f32 v142, v142, v166
    v_cvt_pk_bf16_f32 v133, v136, v138
    v_lshlrev_b32 v136, 16, v133
    v_and_b32 v138, 0xffff0000, v133
    v_cvt_pk_bf16_f32 v133, v140, v142
    v_lshlrev_b32 v140, 16, v133
    v_and_b32 v142, 0xffff0000, v133
    v_add_f32 v140, 1.0, v140
    v_add_f32 v142, 1.0, v142
    v_cvt_pk_bf16_f32 v133, v140, v142
    v_lshlrev_b32 v140, 16, v133
    v_and_b32 v142, 0xffff0000, v133
    v_mul_f32 v118, v118, v140
    v_mul_f32 v119, v119, v142
    v_cvt_pk_bf16_f32 v133, v118, v119
    v_lshlrev_b32 v118, 16, v133
    v_and_b32 v119, 0xffff0000, v133
    v_add_f32 v118, v118, v136
    v_add_f32 v119, v119, v138
    v_cvt_pk_bf16_f32 v118, v118, v119
    v_and_b32 v5, 1, v0
    v_mul_u32_u24 v5, 40, v5
    v_lshrrev_b32 v6, 1, v0
    v_add_u32 v5, v5, v6
    v_lshlrev_b32 v5, 1, v5
    s_mov_b64 exec, s[96:97]
    ds_write_b16 v5, v118 offset:1024
    ds_write_b16_d16_hi v5, v118 offset:1064
    s_mov_b64 exec, -1
    v_lshrrev_b32 v5, 4, v0
    v_mul_u32_u24 v5, 40, v5
    s_waitcnt lgkmcnt(0)

    ds_read_b64 v[88:89], v5 offset:1024
    ds_read_b64 v[90:91], v5 offset:1032
    ds_read_b64 v[92:93], v5 offset:1040
    ds_read_b64 v[94:95], v5 offset:1048
    ds_read_b64 v[96:97], v5 offset:1056
    v_and_b32 v3, 15, v0
    v_lshlrev_b32 v3, 3, v3
    v_lshrrev_b32 v4, 5, v0
    v_lshl_add_u32 v3, v4, 2, v3
    v_bfe_u32 v4, v0, 4, 1
    v_lshl_add_u32 v3, v4, 1, v3

    v_lshlrev_b32 v3, 3, v3
    s_lshl_b32 s24, s33, 3
    s_add_u32 s24, s24, s34
    s_lshl_b32 s24, s24, 10
    s_add_u32 s24, s24, 126976

    s_add_u32 s25, s24, 4194304
    v_mov_b32 v5, s32
    v_mov_b32 v7, s32
    s_waitcnt lgkmcnt(0)

    v_perm_b32 v108, v12, v8, s62
    v_perm_b32 v110, v12, v8, s63
    v_dot2_f32_bf16 v100, v108, v88, 0
    v_dot2_f32_bf16 v101, v110, v88, 0
    v_perm_b32 v109, v13, v9, s62
    v_perm_b32 v111, v13, v9, s63
    v_dot2_f32_bf16 v102, v109, v88, 0
    v_dot2_f32_bf16 v103, v111, v88, 0
    v_perm_b32 v108, v14, v10, s62
    v_perm_b32 v110, v14, v10, s63
    v_dot2_f32_bf16 v104, v108, v88, 0
    v_dot2_f32_bf16 v105, v110, v88, 0
    v_perm_b32 v109, v15, v11, s62
    v_perm_b32 v111, v15, v11, s63
    v_dot2_f32_bf16 v106, v109, v88, 0
    v_dot2_f32_bf16 v107, v111, v88, 0
    v_perm_b32 v108, v20, v16, s62
    v_perm_b32 v110, v20, v16, s63
    v_dot2_f32_bf16 v100, v108, v89, v100
    v_dot2_f32_bf16 v101, v110, v89, v101
    v_perm_b32 v109, v21, v17, s62
    v_perm_b32 v111, v21, v17, s63
    v_dot2_f32_bf16 v102, v109, v89, v102
    v_dot2_f32_bf16 v103, v111, v89, v103
    v_perm_b32 v108, v22, v18, s62
    v_perm_b32 v110, v22, v18, s63
    v_dot2_f32_bf16 v104, v108, v89, v104
    v_dot2_f32_bf16 v105, v110, v89, v105
    v_perm_b32 v109, v23, v19, s62
    v_perm_b32 v111, v23, v19, s63
    v_dot2_f32_bf16 v106, v109, v89, v106
    v_dot2_f32_bf16 v107, v111, v89, v107
    v_perm_b32 v108, v28, v24, s62
    v_perm_b32 v110, v28, v24, s63
    v_dot2_f32_bf16 v100, v108, v90, v100
    v_dot2_f32_bf16 v101, v110, v90, v101
    v_perm_b32 v109, v29, v25, s62
    v_perm_b32 v111, v29, v25, s63
    v_dot2_f32_bf16 v102, v109, v90, v102
    v_dot2_f32_bf16 v103, v111, v90, v103
    v_perm_b32 v108, v30, v26, s62
    v_perm_b32 v110, v30, v26, s63
    v_dot2_f32_bf16 v104, v108, v90, v104
    v_dot2_f32_bf16 v105, v110, v90, v105
    v_perm_b32 v109, v31, v27, s62
    v_perm_b32 v111, v31, v27, s63
    v_dot2_f32_bf16 v106, v109, v90, v106
    v_dot2_f32_bf16 v107, v111, v90, v107
    v_perm_b32 v108, v36, v32, s62
    v_perm_b32 v110, v36, v32, s63
    v_dot2_f32_bf16 v100, v108, v91, v100
    v_dot2_f32_bf16 v101, v110, v91, v101
    v_perm_b32 v109, v37, v33, s62
    v_perm_b32 v111, v37, v33, s63
    v_dot2_f32_bf16 v102, v109, v91, v102
    v_dot2_f32_bf16 v103, v111, v91, v103
    v_perm_b32 v108, v38, v34, s62
    v_perm_b32 v110, v38, v34, s63
    v_dot2_f32_bf16 v104, v108, v91, v104
    v_dot2_f32_bf16 v105, v110, v91, v105
    v_perm_b32 v109, v39, v35, s62
    v_perm_b32 v111, v39, v35, s63
    v_dot2_f32_bf16 v106, v109, v91, v106
    v_dot2_f32_bf16 v107, v111, v91, v107
    v_perm_b32 v108, v44, v40, s62
    v_perm_b32 v110, v44, v40, s63
    v_dot2_f32_bf16 v100, v108, v92, v100
    v_dot2_f32_bf16 v101, v110, v92, v101
    v_perm_b32 v109, v45, v41, s62
    v_perm_b32 v111, v45, v41, s63
    v_dot2_f32_bf16 v102, v109, v92, v102
    v_dot2_f32_bf16 v103, v111, v92, v103
    v_perm_b32 v108, v46, v42, s62
    v_perm_b32 v110, v46, v42, s63
    v_dot2_f32_bf16 v104, v108, v92, v104
    v_dot2_f32_bf16 v105, v110, v92, v105
    v_perm_b32 v109, v47, v43, s62
    v_perm_b32 v111, v47, v43, s63
    v_dot2_f32_bf16 v106, v109, v92, v106
    v_dot2_f32_bf16 v107, v111, v92, v107
    v_perm_b32 v108, v52, v48, s62
    v_perm_b32 v110, v52, v48, s63
    v_dot2_f32_bf16 v100, v108, v93, v100
    v_dot2_f32_bf16 v101, v110, v93, v101
    v_perm_b32 v109, v53, v49, s62
    v_perm_b32 v111, v53, v49, s63
    v_dot2_f32_bf16 v102, v109, v93, v102
    v_dot2_f32_bf16 v103, v111, v93, v103
    v_perm_b32 v108, v54, v50, s62
    v_perm_b32 v110, v54, v50, s63
    v_dot2_f32_bf16 v104, v108, v93, v104
    v_dot2_f32_bf16 v105, v110, v93, v105
    v_perm_b32 v109, v55, v51, s62
    v_perm_b32 v111, v55, v51, s63
    v_dot2_f32_bf16 v106, v109, v93, v106
    v_dot2_f32_bf16 v107, v111, v93, v107
    v_perm_b32 v108, v60, v56, s62
    v_perm_b32 v110, v60, v56, s63
    v_dot2_f32_bf16 v100, v108, v94, v100
    v_dot2_f32_bf16 v101, v110, v94, v101
    v_perm_b32 v109, v61, v57, s62
    v_perm_b32 v111, v61, v57, s63
    v_dot2_f32_bf16 v102, v109, v94, v102
    v_dot2_f32_bf16 v103, v111, v94, v103
    v_perm_b32 v108, v62, v58, s62
    v_perm_b32 v110, v62, v58, s63
    v_dot2_f32_bf16 v104, v108, v94, v104
    v_dot2_f32_bf16 v105, v110, v94, v105
    v_perm_b32 v109, v63, v59, s62
    v_perm_b32 v111, v63, v59, s63
    v_dot2_f32_bf16 v106, v109, v94, v106
    v_dot2_f32_bf16 v107, v111, v94, v107
    v_perm_b32 v108, v68, v64, s62
    v_perm_b32 v110, v68, v64, s63
    v_dot2_f32_bf16 v100, v108, v95, v100
    v_dot2_f32_bf16 v101, v110, v95, v101
    v_perm_b32 v109, v69, v65, s62
    v_perm_b32 v111, v69, v65, s63
    v_dot2_f32_bf16 v102, v109, v95, v102
    v_dot2_f32_bf16 v103, v111, v95, v103
    v_perm_b32 v108, v70, v66, s62
    v_perm_b32 v110, v70, v66, s63
    v_dot2_f32_bf16 v104, v108, v95, v104
    v_dot2_f32_bf16 v105, v110, v95, v105
    v_perm_b32 v109, v71, v67, s62
    v_perm_b32 v111, v71, v67, s63
    v_dot2_f32_bf16 v106, v109, v95, v106
    v_dot2_f32_bf16 v107, v111, v95, v107
    v_perm_b32 v108, v76, v72, s62
    v_perm_b32 v110, v76, v72, s63
    v_dot2_f32_bf16 v100, v108, v96, v100
    v_dot2_f32_bf16 v101, v110, v96, v101
    v_perm_b32 v109, v77, v73, s62
    v_perm_b32 v111, v77, v73, s63
    v_dot2_f32_bf16 v102, v109, v96, v102
    v_dot2_f32_bf16 v103, v111, v96, v103
    v_perm_b32 v108, v78, v74, s62
    v_perm_b32 v110, v78, v74, s63
    v_dot2_f32_bf16 v104, v108, v96, v104
    v_dot2_f32_bf16 v105, v110, v96, v105
    v_perm_b32 v109, v79, v75, s62
    v_perm_b32 v111, v79, v75, s63
    v_dot2_f32_bf16 v106, v109, v96, v106
    v_dot2_f32_bf16 v107, v111, v96, v107
    v_perm_b32 v108, v84, v80, s62
    v_perm_b32 v110, v84, v80, s63
    v_dot2_f32_bf16 v100, v108, v97, v100
    v_dot2_f32_bf16 v101, v110, v97, v101
    v_perm_b32 v109, v85, v81, s62
    v_perm_b32 v111, v85, v81, s63
    v_dot2_f32_bf16 v102, v109, v97, v102
    v_dot2_f32_bf16 v103, v111, v97, v103
    v_perm_b32 v108, v86, v82, s62
    v_perm_b32 v110, v86, v82, s63
    v_dot2_f32_bf16 v104, v108, v97, v104
    v_dot2_f32_bf16 v105, v110, v97, v105
    v_perm_b32 v109, v87, v83, s62
    v_perm_b32 v111, v87, v83, s63
    v_dot2_f32_bf16 v106, v109, v97, v106
    v_dot2_f32_bf16 v107, v111, v97, v107
    s_nop 2
    v_permlane32_swap_b32 v100, v104
    v_permlane32_swap_b32 v101, v105
    v_permlane32_swap_b32 v102, v106
    v_permlane32_swap_b32 v103, v107
    v_add_f32 v100, v100, v104
    v_add_f32 v101, v101, v105
    v_add_f32 v102, v102, v106
    v_add_f32 v103, v103, v107
    s_nop 0
    v_permlane16_swap_b32 v100, v102
    v_permlane16_swap_b32 v101, v103
    s_nop 0
    v_add_f32 v100, v100, v102
    v_add_f32 v101, v101, v103
    v_mov_b32 v4, v100
    v_mov_b32 v6, v101
    buffer_store_dwordx4 v[4:7], v3, s[16:19], s25 offen
    buffer_store_dwordx4 v[4:7], v3, s[16:19], s24 offen sc1

    v_mov_b32 v8, 1
    ds_write_b32 v2, v8 offset:24
    s_mov_b32 s20, s50
    s_mov_b32 s21, s51
    s_mov_b32 s22, 2211840
    s_mov_b32 s23, 0x00020000

    s_cmp_ge_u32 s35, 54
    s_cbranch_scc1 Lnomlp_130
    s_mul_i32 s28, s35, 40960
    s_mov_b32 s29, 69632

    s_mov_b32 s5, 0
Lspin_131:
    ds_read_b32 v8, v2 offset:40
    s_waitcnt lgkmcnt(0)
    v_readfirstlane_b32 s6, v8
    s_cmp_ge_u32 s6, 8
    s_cbranch_scc1 Lok_132
    s_sleep 4
    s_add_u32 s5, s5, 1
    s_cmp_lt_u32 s5, 1600000
    s_cbranch_scc1 Lspin_131
Lok_132:
    s_mov_b32 s5, 0
Lspin_133:
    ds_read_b32 v8, v2 offset:56
    s_waitcnt lgkmcnt(0)
    v_readfirstlane_b32 s6, v8
    s_cmp_ge_u32 s6, 1
    s_cbranch_scc1 Lok_134
    s_sleep 2
    s_add_u32 s5, s5, 1
    s_cmp_lt_u32 s5, 1600000
    s_cbranch_scc1 Lspin_133
Lok_134:
Lw2_135:
    s_mov_b32 m0, s29
    s_add_u32 s29, s29, 1024
    buffer_load_dwordx4 v1, s[20:23], s28 offen  lds
    s_add_u32 s28, s28, 1024
    s_cmp_lt_u32 s29, 110592
    s_cbranch_scc1 Lw2_135
    s_waitcnt vmcnt(0)

    v_mov_b32 v4, 1
    s_mov_b64 exec, 1
    ds_add_u32 v2, v4 offset:44
    s_mov_b64 exec, -1
    s_waitcnt lgkmcnt(0)
Lnomlp_130:
    s_branch L_end
L_w10:
    v_lshlrev_b32 v3, 2, v0
    v_mov_b32 v4, 0
    s_mov_b64 exec, 0xffff
    ds_write_b32 v3, v4
    s_mov_b64 exec, -1
    s_waitcnt lgkmcnt(0)
    s_barrier
    s_mul_i32 s32, s32, 0x9e3779b1
    s_add_u32 s32, s32, 0x7f4a7c15
    s_lshl_b32 s20, s33, 13
    s_add_u32 s20, s20, 126976
    s_add_u32 s21, s20, 4096

    s_add_u32 s8, s60, 4194304
    s_addc_u32 s9, s61, 0
    s_mov_b32 s10, 532676608
    s_mov_b32 s11, 0x00020000

    s_mov_b32 s5, 0
Lspin_136:
    ds_read_b32 v6, v2 offset:24
    s_waitcnt lgkmcnt(0)
    v_readfirstlane_b32 s6, v6
    s_cmp_ge_u32 s6, 1
    s_cbranch_scc1 Lok_137
    s_sleep 4
    s_add_u32 s5, s5, 1
    s_cmp_lt_u32 s5, 1600000
    s_cbranch_scc1 Lspin_136
Lok_137:
    s_mov_b32 s5, 0
Lpoll_138:
    buffer_load_dwordx4 v[8:11], v1, s[8:11], s20 offen offset:0 sc1
    buffer_load_dwordx4 v[12:15], v1, s[8:11], s20 offen offset:1024 sc1
    buffer_load_dwordx4 v[16:19], v1, s[8:11], s20 offen offset:2048 sc1
    buffer_load_dwordx4 v[20:23], v1, s[8:11], s20 offen offset:3072 sc1
    buffer_load_dwordx4 v[24:27], v1, s[8:11], s21 offen offset:0 sc1
    buffer_load_dwordx4 v[28:31], v1, s[8:11], s21 offen offset:1024 sc1
    buffer_load_dwordx4 v[32:35], v1, s[8:11], s21 offen offset:2048 sc1
    buffer_load_dwordx4 v[36:39], v1, s[8:11], s21 offen offset:3072 sc1
    s_waitcnt vmcnt(0)
    v_min3_u32 v40, v9, v11, v13
    v_min3_u32 v40, v40, v15, v17
    v_min3_u32 v40, v40, v19, v21
    v_min3_u32 v40, v40, v23, v25
    v_min3_u32 v40, v40, v27, v29
    v_min3_u32 v40, v40, v31, v33
    v_min3_u32 v40, v40, v35, v37
    v_min_u32 v40, v40, v39
    v_max3_u32 v41, v9, v11, v13
    v_max3_u32 v41, v41, v15, v17
    v_max3_u32 v41, v41, v19, v21
    v_max3_u32 v41, v41, v23, v25
    v_max3_u32 v41, v41, v27, v29
    v_max3_u32 v41, v41, v31, v33
    v_max3_u32 v41, v41, v35, v37
    v_max_u32 v41, v41, v39
    v_cmp_ne_u32 s[30:31], s32, v40
    v_cmp_ne_u32 s[6:7], s32, v41
    s_or_b64 s[30:31], s[30:31], s[6:7]
    s_cmp_eq_u64 s[30:31], 0
    s_cbranch_scc1 Lok_139
    s_sleep 2
    s_add_u32 s5, s5, 1
    s_cmp_ge_u32 s5, 6
    s_cselect_b32 s4, s5, 0
    s_and_b32 s4, s4, 1
    s_xor_b32 s4, s4, 1
    s_lshl_b32 s4, s4, 22
    s_add_u32 s8, s60, s4
    s_addc_u32 s9, s61, 0
    s_cmp_lt_u32 s5, 400000
    s_cbranch_scc1 Lpoll_138

Lok_139:
    s_cmp_eq_u32 s8, s60
    s_cselect_b32 s100, 64, 0
    v_add_f32 v8, v8, v12
    v_add_f32 v10, v10, v14
    v_add_f32 v8, v8, v16
    v_add_f32 v10, v10, v18
    v_add_f32 v8, v8, v20
    v_add_f32 v10, v10, v22
    v_add_f32 v8, v8, v24
    v_add_f32 v10, v10, v26
    v_add_f32 v8, v8, v28
    v_add_f32 v10, v10, v30
    v_add_f32 v8, v8, v32
    v_add_f32 v10, v10, v34
    v_add_f32 v8, v8, v36
    v_add_f32 v10, v10, v38
    v_cvt_pk_bf16_f32 v8, v8, v10
    ds_write_b32 v3, v8 offset:256
    s_waitcnt lgkmcnt(0)

    v_mov_b32 v4, 1
    ds_write_b32 v2, v4 offset:0
    s_add_u32 s8, s60, 4194304
    s_addc_u32 s9, s61, 0
    s_mov_b32 s10, 532676608
    s_mov_b32 s11, 0x00020000

    s_lshl_b32 s24, s33, 3
    s_add_u32 s24, s24, s34
    s_lshl_b32 s24, s24, 4
    s_add_u32 s24, s24, 389120

    s_add_u32 s25, s24, 4194304
    s_mov_b32 s5, 0
Lspin_140:
    ds_read_b32 v4, v2 offset:8
    s_waitcnt lgkmcnt(0)
    v_readfirstlane_b32 s6, v4
    s_cmp_ge_u32 s6, 8
    s_cbranch_scc1 Lok_141
    s_sleep 2
    s_add_u32 s5, s5, 1
    s_cmp_lt_u32 s5, 1600000
    s_cbranch_scc1 Lspin_140
Lok_141:
    v_and_b32 v4, 7, v0
    v_lshlrev_b32 v4, 3, v4
    ds_read_b64 v[8:9], v4 offset:64
    s_waitcnt lgkmcnt(0)
    v_mov_b32 v10, v8

    s_nop 0
    s_nop 1
    v_max_f32_dpp v10, v10, v10 quad_perm:[1,0,3,2] row_mask:0xf bank_mask:0xf
    s_nop 1
    v_max_f32_dpp v10, v10, v10 quad_perm:[2,3,0,1] row_mask:0xf bank_mask:0xf
    s_nop 1
    v_max_f32_dpp v10, v10, v10 row_half_mirror row_mask:0xf bank_mask:0xf
    s_nop 0
    v_sub_f32 v11, v8, v10
    v_mul_f32 v11, 1069066811, v11
    v_exp_f32 v11, v11
    s_nop 0
    v_mul_f32 v9, v9, v11

    s_nop 0
    s_nop 1
    v_add_f32_dpp v9, v9, v9 quad_perm:[1,0,3,2] row_mask:0xf bank_mask:0xf
    s_nop 1
    v_add_f32_dpp v9, v9, v9 quad_perm:[2,3,0,1] row_mask:0xf bank_mask:0xf
    s_nop 1
    v_add_f32_dpp v9, v9, v9 row_half_mirror row_mask:0xf bank_mask:0xf
    s_nop 0
    ds_write_b32 v2, v10 offset:128
    v_mov_b32 v12, v10
    v_mov_b32 v13, s32
    v_mov_b32 v14, v9
    v_mov_b32 v15, s32
    s_mov_b64 exec, 1
    buffer_store_dwordx4 v[12:15], v2, s[16:19], s25 offen
    buffer_store_dwordx4 v[12:15], v2, s[16:19], s24 offen sc1
    s_mov_b64 exec, -1

    s_add_u32 s100, s100, 1
    v_mov_b32 v4, s100
    ds_write_b32 v2, v4 offset:4
    s_waitcnt lgkmcnt(0)
    s_branch L_end
L_w11:
    s_mov_b32 s12, s36
    s_mov_b32 s13, s37
    s_mov_b32 s14, 1280
    s_mov_b32 s15, 0x00020000

    s_cmp_lt_u32 s35, 54
    s_cbranch_scc1 L_w11_mlp
    s_sub_u32 s35, s35, 54
    s_cmp_lt_u32 s35, 20
    s_cbranch_scc1 L_w11_red
    s_branch L_end

L_w11_red:
    v_lshrrev_b32 v3, 4, v0
    v_mul_u32_u24 v3, 5120, v3
    v_and_b32 v4, 15, v0
    v_lshl_add_u32 v3, v4, 4, v3
    s_lshl_b32 s20, s35, 8
    s_add_u32 s20, s20, 14336
    v_lshlrev_b32 v5, 2, v4
    s_lshl_b32 s4, s35, 6
    buffer_load_dword v30, v5, s[12:15], s4 offen

    s_mov_b32 s5, 0
Lspin_142:
    ds_read_b32 v6, v2 offset:24
    s_waitcnt lgkmcnt(0)
    v_readfirstlane_b32 s6, v6
    s_cmp_ge_u32 s6, 1
    s_cbranch_scc1 Lok_143
    s_sleep 8
    s_add_u32 s5, s5, 1
    s_cmp_lt_u32 s5, 1600000
    s_cbranch_scc1 Lspin_142
Lok_143:
    s_mov_b32 s5, 0
Lpoll_144:
    s_add_u32 s4, s20, 0
    buffer_load_dwordx4 v[8:11], v3, s[16:19], s4 offen sc1
    s_add_u32 s4, s20, 30720
    buffer_load_dwordx4 v[12:15], v3, s[16:19], s4 offen sc1
    s_add_u32 s4, s20, 61440
    buffer_load_dwordx4 v[16:19], v3, s[16:19], s4 offen sc1
    s_add_u32 s4, s20, 92160
    buffer_load_dwordx4 v[20:23], v3, s[16:19], s4 offen sc1
    s_waitcnt vmcnt(0)
    v_cmp_ne_u32 s[30:31], s32, v9
    v_cmp_ne_u32 s[6:7], s32, v11
    s_or_b64 s[30:31], s[30:31], s[6:7]
    v_cmp_ne_u32 s[6:7], s32, v13
    s_or_b64 s[30:31], s[30:31], s[6:7]
    v_cmp_ne_u32 s[6:7], s32, v15
    s_or_b64 s[30:31], s[30:31], s[6:7]
    v_cmp_ne_u32 s[6:7], s32, v17
    s_or_b64 s[30:31], s[30:31], s[6:7]
    v_cmp_ne_u32 s[6:7], s32, v19
    s_or_b64 s[30:31], s[30:31], s[6:7]
    v_cmp_ne_u32 s[6:7], s32, v21
    s_or_b64 s[30:31], s[30:31], s[6:7]
    v_cmp_ne_u32 s[6:7], s32, v23
    s_or_b64 s[30:31], s[30:31], s[6:7]
    s_cmp_eq_u64 s[30:31], 0
    s_cbranch_scc1 Lok_145
    s_sleep 8
    s_add_u32 s5, s5, 1
    s_cmp_lt_u32 s5, 400000
    s_cbranch_scc1 Lpoll_144
Lok_145:
    v_add_f32 v8, v8, v12
    v_add_f32 v10, v10, v14
    v_add_f32 v8, v8, v16
    v_add_f32 v10, v10, v18
    v_add_f32 v8, v8, v20
    v_add_f32 v10, v10, v22
    v_cvt_pk_bf16_f32 v12, v8, v10
    v_lshlrev_b32 v8, 16, v12
    v_and_b32 v9, 0xffff0000, v12
    v_lshlrev_b32 v5, 3, v0
    ds_write_b64 v5, v[8:9] offset:7168
    v_lshlrev_b32 v5, 3, v4
    s_waitcnt lgkmcnt(0)
    ds_read_b64 v[8:9], v5 offset:7168
    ds_read_b64 v[10:11], v5 offset:7296
    ds_read_b64 v[12:13], v5 offset:7424
    ds_read_b64 v[14:15], v5 offset:7552
    v_lshlrev_b32 v16, 16, v30
    v_and_b32 v17, 0xffff0000, v30
    s_waitcnt lgkmcnt(0)
    ds_write_b64 v5, v[8:9] offset:1408
    ds_write_b64 v5, v[14:15] offset:1536
    ds_write_b64 v5, v[16:17] offset:1664
    v_add_f32 v12, 1.0, v12
    v_add_f32 v13, 1.0, v13
    v_cvt_pk_bf16_f32 v20, v12, v10
    v_mov_b32 v21, s32
    v_mov_b32 v22, v8
    v_mov_b32 v23, s32
    v_cvt_pk_bf16_f32 v24, v13, v11
    v_mov_b32 v25, s32
    v_mov_b32 v26, v9
    v_mov_b32 v27, s32
    v_lshlrev_b32 v5, 5, v0
    s_lshl_b32 s4, s35, 9
    s_add_u32 s4, s4, 696320
    s_mov_b64 exec, 0xffff
    buffer_store_dwordx4 v[20:23], v5, s[16:19], s4 offen sc1
    buffer_store_dwordx4 v[24:27], v5, s[16:19], s4 offen offset:16 sc1
    s_mov_b64 exec, -1
    s_waitcnt lgkmcnt(0)

    v_mov_b32 v4, 1
    ds_write_b32 v2, v4 offset:12
    s_waitcnt lgkmcnt(0)
    s_branch L_end
L_w11_mlp:
    s_mov_b32 s21, 696320
    s_mov_b32 s22, 700416
    s_mov_b32 s23, 704512
    v_lshlrev_b32 v5, 8, v0
    v_cmp_gt_u32 s[96:97], 40, v0
    v_mov_b32 v4, 2147483392
    s_nop 0
    v_cndmask_b32 v5, v4, v5, s[96:97]

    s_mov_b32 s5, 0
Lspin_146:
    ds_read_b32 v6, v2 offset:24
    s_waitcnt lgkmcnt(0)
    v_readfirstlane_b32 s6, v6
    s_cmp_ge_u32 s6, 1
    s_cbranch_scc1 Lok_147
    s_sleep 8
    s_add_u32 s5, s5, 1
    s_cmp_lt_u32 s5, 1600000
    s_cbranch_scc1 Lspin_146
Lok_147:
    s_mov_b32 s5, 0
Lpoll_148:
    buffer_load_dwordx2 v[8:9], v5, s[16:19], s21 offen sc1
    s_waitcnt vmcnt(0)
    v_cmp_ne_u32 s[30:31], s32, v9
    s_and_b64 s[30:31], s[30:31], s[96:97]
    s_cmp_eq_u64 s[30:31], 0
    s_cbranch_scc1 Lok_149
    s_sleep 8
    s_add_u32 s5, s5, 1
    s_cmp_lt_u32 s5, 400000
    s_cbranch_scc1 Lpoll_148
Lok_149:
    s_mov_b32 s5, 0
Lpoll_150:
    buffer_load_dwordx4 v[8:11], v1, s[16:19], s21 offen offset:0 sc1
    buffer_load_dwordx4 v[12:15], v1, s[16:19], s21 offen offset:1024 sc1
    buffer_load_dwordx4 v[16:19], v1, s[16:19], s21 offen offset:2048 sc1
    buffer_load_dwordx4 v[20:23], v1, s[16:19], s21 offen offset:3072 sc1
    buffer_load_dwordx4 v[24:27], v1, s[16:19], s22 offen offset:0 sc1
    buffer_load_dwordx4 v[28:31], v1, s[16:19], s22 offen offset:1024 sc1
    buffer_load_dwordx4 v[32:35], v1, s[16:19], s22 offen offset:2048 sc1
    buffer_load_dwordx4 v[36:39], v1, s[16:19], s22 offen offset:3072 sc1
    buffer_load_dwordx4 v[40:43], v1, s[16:19], s23 offen offset:0 sc1
    buffer_load_dwordx4 v[44:47], v1, s[16:19], s23 offen offset:1024 sc1
    s_waitcnt vmcnt(0)
    v_min3_u32 v50, v9, v11, v13
    v_min3_u32 v50, v50, v15, v17
    v_min3_u32 v50, v50, v19, v21
    v_min3_u32 v50, v50, v23, v25
    v_min3_u32 v50, v50, v27, v29
    v_min3_u32 v50, v50, v31, v33
    v_min3_u32 v50, v50, v35, v37
    v_min3_u32 v50, v50, v39, v41
    v_min3_u32 v50, v50, v43, v45
    v_min_u32 v50, v50, v47
    v_max3_u32 v51, v9, v11, v13
    v_max3_u32 v51, v51, v15, v17
    v_max3_u32 v51, v51, v19, v21
    v_max3_u32 v51, v51, v23, v25
    v_max3_u32 v51, v51, v27, v29
    v_max3_u32 v51, v51, v31, v33
    v_max3_u32 v51, v51, v35, v37
    v_max3_u32 v51, v51, v39, v41
    v_max3_u32 v51, v51, v43, v45
    v_max_u32 v51, v51, v47
    v_cmp_ne_u32 s[30:31], s32, v50
    v_cmp_ne_u32 s[6:7], s32, v51
    s_or_b64 s[30:31], s[30:31], s[6:7]
    s_cmp_eq_u64 s[30:31], 0
    s_cbranch_scc1 Lok_151
    s_sleep 4
    s_add_u32 s5, s5, 1
    s_cmp_lt_u32 s5, 400000
    s_cbranch_scc1 Lpoll_150
Lok_151:
    v_lshlrev_b32 v4, 2, v0
    ds_write_b32 v4, v8 offset:2048
    ds_write_b32 v4, v10 offset:4608
    ds_write_b32 v4, v12 offset:2304
    ds_write_b32 v4, v14 offset:4864
    ds_write_b32 v4, v16 offset:2560
    ds_write_b32 v4, v18 offset:5120
    ds_write_b32 v4, v20 offset:2816
    ds_write_b32 v4, v22 offset:5376
    ds_write_b32 v4, v24 offset:3072
    ds_write_b32 v4, v26 offset:5632
    ds_write_b32 v4, v28 offset:3328
    ds_write_b32 v4, v30 offset:5888
    ds_write_b32 v4, v32 offset:3584
    ds_write_b32 v4, v34 offset:6144
    ds_write_b32 v4, v36 offset:3840
    ds_write_b32 v4, v38 offset:6400
    ds_write_b32 v4, v40 offset:4096
    ds_write_b32 v4, v42 offset:6656
    ds_write_b32 v4, v44 offset:4352
    ds_write_b32 v4, v46 offset:6912
    s_waitcnt lgkmcnt(0)
    v_mov_b32 v4, 1
    ds_write_b32 v2, v4 offset:12
    s_waitcnt lgkmcnt(0)
L_end:
    s_endpgm
.section .rodata,"a"
.p2align 6
.amdhsa_kernel adaLN_cond__sliding_block_cached__dense_activation_relu__decode_kernel
  .amdhsa_next_free_vgpr 168
  .amdhsa_next_free_sgpr 102
  .amdhsa_accum_offset 168
  .amdhsa_group_segment_fixed_size 0
  .amdhsa_kernarg_size 104
  .amdhsa_user_sgpr_count 2
  .amdhsa_user_sgpr_kernarg_segment_ptr 1
  .amdhsa_system_sgpr_workgroup_id_x 1
  .amdhsa_float_denorm_mode_32 3
  .amdhsa_float_denorm_mode_16_64 3
.end_amdhsa_kernel
```
